```python
import torch

def _softmax(x, axis=-1):
    return torch.softmax(x, dim=axis)

def _gelu(x):
    return torch.nn.functional.gelu(x, approximate='tanh')

def _silu(x):
    return torch.nn.functional.silu(x)

def _sigmoid(x):
    return torch.sigmoid(x)

def _layernorm(x, axis=-1, eps=1e-05):
    m = x.mean(dim=axis, keepdim=True)
    v = x.var(dim=axis, keepdim=True, unbiased=False)
    return (x - m) / torch.sqrt(v + eps)

def _scatter_add(tgt, idx, src, axis=0):
    return tgt.clone().index_add_(axis, idx, src)

def _segment_sum(src, seg, n):
    out = torch.zeros((n,) + src.shape[1:], dtype=src.dtype)
    return out.index_add_(0, seg, src)

def _pad(x, pw):
    flat = tuple((v for pair in reversed(pw) for v in pair))
    return torch.nn.functional.pad(x, flat)
kernel_name = 'standalone__ragged_sequences_varlen_flash_attn__ragged'

def setup_inputs():

    _w = lambda a: (lambda t: t.to(torch.bfloat16) if t.is_floating_point() else t)(torch.as_tensor(a))
    cu = torch.tensor([0, 485, 1609, 2680, 3050, 3769, 5493, 6501, 7684], dtype=torch.int64)
    T = int(cu[-1])
    Hq, Hkv, D = (16, 8, 128)
    assert Hq % Hkv == 0
    return {'q': _w((lambda *s: torch.randn(*s, dtype=torch.bfloat16) * 0.8)(T, Hq, D)), 'k': _w((lambda *s: torch.randn(*s, dtype=torch.bfloat16) * 0.8)(T, Hkv, D)), 'v': _w((lambda *s: torch.randn(*s, dtype=torch.bfloat16) * 0.05)(T, Hkv, D)), 'cu': _w(cu)}

def reference(q, k, v, cu):
    T, Hq, D = q.shape
    Hkv = k.shape[1]
    rep = Hq // Hkv
    scale = D ** (-0.5)
    outs = []
    for i in range(len(cu) - 1):
        s, e = (int(cu[i]), int(cu[i + 1]))
        L = e - s
        qi = q[s:e].clone()
        ki = (lambda x, n, axis: torch.repeat_interleave(x, n, dim=axis))(k[s:e], rep, axis=1)
        vi = (lambda x, n, axis: torch.repeat_interleave(x, n, dim=axis))(v[s:e], rep, axis=1)
        logits = torch.einsum('qhd,khd->hqk', qi, ki) * scale
        ar = torch.arange(L)
        neg = (lambda x, dt: x.to(dt))(ar[None, :] > ar[:, None], logits.dtype) * -1000000000.0
        p = _softmax(logits + neg[None, :, :], axis=-1)
        outs.append(torch.einsum('hqk,khd->qhd', p, vi))
    return torch.concatenate(outs, axis=0)
```

```asm
; @launch grid=(512,1,1) block=(256,1,1) lds=66048
.amdgcn_target "amdgcn-amd-amdhsa--gfx950"
.text
.globl standalone__ragged_sequences_varlen_flash_attn__ragged_kernel
.p2align 8
.type standalone__ragged_sequences_varlen_flash_attn__ragged_kernel,@function
standalone__ragged_sequences_varlen_flash_attn__ragged_kernel:
    s_load_dwordx2 s[8:9], s[0:1], 0
    s_load_dwordx2 s[12:13], s[0:1], 8
    s_load_dwordx2 s[16:17], s[0:1], 16
    s_load_dwordx2 s[24:25], s[0:1], 24
    s_load_dwordx2 s[20:21], s[0:1], 32
    s_and_b32 s26, s2, 7
    s_lshr_b32 s89, s2, 3
    s_cmp_ge_u32 s89, 64
    s_cbranch_scc1 L_exit
    v_and_b32 v251, 63, v0
    v_lshrrev_b32 v243, 6, v0
    s_nop 0
    v_readfirstlane_b32 s41, v243
    s_waitcnt lgkmcnt(0)
    s_load_dwordx8 s[32:39], s[24:25], 0
    s_load_dword s40, s[24:25], 32
    s_mov_b32 s10, 31473664
    s_mov_b32 s11, 0x00020000
    s_mov_b32 s14, 15736832
    s_mov_b32 s15, 0x00020000
    s_mov_b32 s18, 15736832
    s_mov_b32 s19, 0x00020000
    s_mov_b32 s22, 31473664
    s_mov_b32 s23, 0x00020000
    s_lshr_b32 s42, s41, 1
    s_and_b32 s43, s41, 1
    s_mov_b32 s53, 0x3e0293ee
    s_mov_b32 s54, 0x427af233
    s_mov_b32 s56, 0
    s_mov_b32 s86, 0
    s_mov_b32 s85, 0
    s_sub_u32 s27, 127, s89
    s_waitcnt lgkmcnt(0)
    s_sub_u32 s44, s33, s32
    s_add_u32 s44, s44, 63
    s_lshr_b32 s44, s44, 6
    s_sub_u32 s45, s34, s33
    s_add_u32 s45, s45, 63
    s_lshr_b32 s45, s45, 6
    s_sub_u32 s46, s35, s34
    s_add_u32 s46, s46, 63
    s_lshr_b32 s46, s46, 6
    s_sub_u32 s47, s36, s35
    s_add_u32 s47, s47, 63
    s_lshr_b32 s47, s47, 6
    s_sub_u32 s48, s37, s36
    s_add_u32 s48, s48, 63
    s_lshr_b32 s48, s48, 6
    s_sub_u32 s49, s38, s37
    s_add_u32 s49, s49, 63
    s_lshr_b32 s49, s49, 6
    s_sub_u32 s50, s39, s38
    s_add_u32 s50, s50, 63
    s_lshr_b32 s50, s50, 6
    s_sub_u32 s51, s40, s39
    s_add_u32 s51, s51, 63
    s_lshr_b32 s51, s51, 6
    v_mov_b32 v243, 0
    v_mov_b32 v244, 0
    v_add_u32 v246, 64, v251
    v_sub_u32 v245, s44, v251
    v_max_i32 v245, 0, v245
    v_add_u32 v243, v243, v245
    v_sub_u32 v245, s44, v246
    v_max_i32 v245, 0, v245
    v_add_u32 v244, v244, v245
    v_sub_u32 v245, s45, v251
    v_max_i32 v245, 0, v245
    v_add_u32 v243, v243, v245
    v_sub_u32 v245, s45, v246
    v_max_i32 v245, 0, v245
    v_add_u32 v244, v244, v245
    v_sub_u32 v245, s46, v251
    v_max_i32 v245, 0, v245
    v_add_u32 v243, v243, v245
    v_sub_u32 v245, s46, v246
    v_max_i32 v245, 0, v245
    v_add_u32 v244, v244, v245
    v_sub_u32 v245, s47, v251
    v_max_i32 v245, 0, v245
    v_add_u32 v243, v243, v245
    v_sub_u32 v245, s47, v246
    v_max_i32 v245, 0, v245
    v_add_u32 v244, v244, v245
    v_sub_u32 v245, s48, v251
    v_max_i32 v245, 0, v245
    v_add_u32 v243, v243, v245
    v_sub_u32 v245, s48, v246
    v_max_i32 v245, 0, v245
    v_add_u32 v244, v244, v245
    v_sub_u32 v245, s49, v251
    v_max_i32 v245, 0, v245
    v_add_u32 v243, v243, v245
    v_sub_u32 v245, s49, v246
    v_max_i32 v245, 0, v245
    v_add_u32 v244, v244, v245
    v_sub_u32 v245, s50, v251
    v_max_i32 v245, 0, v245
    v_add_u32 v243, v243, v245
    v_sub_u32 v245, s50, v246
    v_max_i32 v245, 0, v245
    v_add_u32 v244, v244, v245
    v_sub_u32 v245, s51, v251
    v_max_i32 v245, 0, v245
    v_add_u32 v243, v243, v245
    v_sub_u32 v245, s51, v246
    v_max_i32 v245, 0, v245
    v_add_u32 v244, v244, v245
    v_cmp_lt_u32 s[64:65], s89, v243
    v_cmp_lt_u32 s[66:67], s89, v244
    s_nop 1
    s_bcnt1_i32_b64 s62, s[64:65]
    s_bcnt1_i32_b64 s63, s[66:67]
    s_add_u32 s29, s62, s63
    s_mov_b32 s30, 0
    s_mov_b32 s31, 0
    s_mov_b32 s28, 0
    s_cmp_eq_u32 s29, 0
    s_cbranch_scc1 L_schd1
    s_sub_u32 s28, s29, 1
    s_mov_b32 s62, 0
    s_sub_i32 s63, s44, s29
    s_max_i32 s63, s63, 0
    s_add_u32 s62, s62, s63
    s_sub_i32 s63, s45, s29
    s_max_i32 s63, s63, 0
    s_add_u32 s62, s62, s63
    s_sub_i32 s63, s46, s29
    s_max_i32 s63, s63, 0
    s_add_u32 s62, s62, s63
    s_sub_i32 s63, s47, s29
    s_max_i32 s63, s63, 0
    s_add_u32 s62, s62, s63
    s_sub_i32 s63, s48, s29
    s_max_i32 s63, s63, 0
    s_add_u32 s62, s62, s63
    s_sub_i32 s63, s49, s29
    s_max_i32 s63, s63, 0
    s_add_u32 s62, s62, s63
    s_sub_i32 s63, s50, s29
    s_max_i32 s63, s63, 0
    s_add_u32 s62, s62, s63
    s_sub_i32 s63, s51, s29
    s_max_i32 s63, s63, 0
    s_add_u32 s62, s62, s63
    s_sub_u32 s62, s89, s62
    s_cmp_gt_u32 s44, s28
    s_cselect_b32 s63, 1, 0
    s_cmp_eq_u32 s62, 0
    s_cselect_b32 s70, s63, 0
    s_sub_u32 s71, s33, s32
    s_cmp_lg_u32 s70, 0
    s_cselect_b32 s30, s32, s30
    s_cselect_b32 s31, s71, s31
    s_sub_u32 s62, s62, s63
    s_cmp_gt_u32 s45, s28
    s_cselect_b32 s63, 1, 0
    s_cmp_eq_u32 s62, 0
    s_cselect_b32 s70, s63, 0
    s_sub_u32 s71, s34, s33
    s_cmp_lg_u32 s70, 0
    s_cselect_b32 s30, s33, s30
    s_cselect_b32 s31, s71, s31
    s_sub_u32 s62, s62, s63
    s_cmp_gt_u32 s46, s28
    s_cselect_b32 s63, 1, 0
    s_cmp_eq_u32 s62, 0
    s_cselect_b32 s70, s63, 0
    s_sub_u32 s71, s35, s34
    s_cmp_lg_u32 s70, 0
    s_cselect_b32 s30, s34, s30
    s_cselect_b32 s31, s71, s31
    s_sub_u32 s62, s62, s63
    s_cmp_gt_u32 s47, s28
    s_cselect_b32 s63, 1, 0
    s_cmp_eq_u32 s62, 0
    s_cselect_b32 s70, s63, 0
    s_sub_u32 s71, s36, s35
    s_cmp_lg_u32 s70, 0
    s_cselect_b32 s30, s35, s30
    s_cselect_b32 s31, s71, s31
    s_sub_u32 s62, s62, s63
    s_cmp_gt_u32 s48, s28
    s_cselect_b32 s63, 1, 0
    s_cmp_eq_u32 s62, 0
    s_cselect_b32 s70, s63, 0
    s_sub_u32 s71, s37, s36
    s_cmp_lg_u32 s70, 0
    s_cselect_b32 s30, s36, s30
    s_cselect_b32 s31, s71, s31
    s_sub_u32 s62, s62, s63
    s_cmp_gt_u32 s49, s28
    s_cselect_b32 s63, 1, 0
    s_cmp_eq_u32 s62, 0
    s_cselect_b32 s70, s63, 0
    s_sub_u32 s71, s38, s37
    s_cmp_lg_u32 s70, 0
    s_cselect_b32 s30, s37, s30
    s_cselect_b32 s31, s71, s31
    s_sub_u32 s62, s62, s63
    s_cmp_gt_u32 s50, s28
    s_cselect_b32 s63, 1, 0
    s_cmp_eq_u32 s62, 0
    s_cselect_b32 s70, s63, 0
    s_sub_u32 s71, s39, s38
    s_cmp_lg_u32 s70, 0
    s_cselect_b32 s30, s38, s30
    s_cselect_b32 s31, s71, s31
    s_sub_u32 s62, s62, s63
    s_cmp_gt_u32 s51, s28
    s_cselect_b32 s63, 1, 0
    s_cmp_eq_u32 s62, 0
    s_cselect_b32 s70, s63, 0
    s_sub_u32 s71, s40, s39
    s_cmp_lg_u32 s70, 0
    s_cselect_b32 s30, s39, s30
    s_cselect_b32 s31, s71, s31
    s_sub_u32 s62, s62, s63
L_schd1:
    s_cmp_eq_u32 s29, 0
    s_cbranch_scc1 L_exit
    v_cmp_lt_u32 s[64:65], s27, v243
    v_cmp_lt_u32 s[66:67], s27, v244
    s_nop 1
    s_bcnt1_i32_b64 s62, s[64:65]
    s_bcnt1_i32_b64 s63, s[66:67]
    s_add_u32 s84, s62, s63
    s_mov_b32 s73, 0
    s_mov_b32 s74, 0
    s_mov_b32 s75, 0
    s_cmp_eq_u32 s84, 0
    s_cbranch_scc1 L_schd2
    s_sub_u32 s75, s84, 1
    s_mov_b32 s62, 0
    s_sub_i32 s63, s44, s84
    s_max_i32 s63, s63, 0
    s_add_u32 s62, s62, s63
    s_sub_i32 s63, s45, s84
    s_max_i32 s63, s63, 0
    s_add_u32 s62, s62, s63
    s_sub_i32 s63, s46, s84
    s_max_i32 s63, s63, 0
    s_add_u32 s62, s62, s63
    s_sub_i32 s63, s47, s84
    s_max_i32 s63, s63, 0
    s_add_u32 s62, s62, s63
    s_sub_i32 s63, s48, s84
    s_max_i32 s63, s63, 0
    s_add_u32 s62, s62, s63
    s_sub_i32 s63, s49, s84
    s_max_i32 s63, s63, 0
    s_add_u32 s62, s62, s63
    s_sub_i32 s63, s50, s84
    s_max_i32 s63, s63, 0
    s_add_u32 s62, s62, s63
    s_sub_i32 s63, s51, s84
    s_max_i32 s63, s63, 0
    s_add_u32 s62, s62, s63
    s_sub_u32 s62, s27, s62
    s_cmp_gt_u32 s44, s75
    s_cselect_b32 s63, 1, 0
    s_cmp_eq_u32 s62, 0
    s_cselect_b32 s70, s63, 0
    s_sub_u32 s71, s33, s32
    s_cmp_lg_u32 s70, 0
    s_cselect_b32 s73, s32, s73
    s_cselect_b32 s74, s71, s74
    s_sub_u32 s62, s62, s63
    s_cmp_gt_u32 s45, s75
    s_cselect_b32 s63, 1, 0
    s_cmp_eq_u32 s62, 0
    s_cselect_b32 s70, s63, 0
    s_sub_u32 s71, s34, s33
    s_cmp_lg_u32 s70, 0
    s_cselect_b32 s73, s33, s73
    s_cselect_b32 s74, s71, s74
    s_sub_u32 s62, s62, s63
    s_cmp_gt_u32 s46, s75
    s_cselect_b32 s63, 1, 0
    s_cmp_eq_u32 s62, 0
    s_cselect_b32 s70, s63, 0
    s_sub_u32 s71, s35, s34
    s_cmp_lg_u32 s70, 0
    s_cselect_b32 s73, s34, s73
    s_cselect_b32 s74, s71, s74
    s_sub_u32 s62, s62, s63
    s_cmp_gt_u32 s47, s75
    s_cselect_b32 s63, 1, 0
    s_cmp_eq_u32 s62, 0
    s_cselect_b32 s70, s63, 0
    s_sub_u32 s71, s36, s35
    s_cmp_lg_u32 s70, 0
    s_cselect_b32 s73, s35, s73
    s_cselect_b32 s74, s71, s74
    s_sub_u32 s62, s62, s63
    s_cmp_gt_u32 s48, s75
    s_cselect_b32 s63, 1, 0
    s_cmp_eq_u32 s62, 0
    s_cselect_b32 s70, s63, 0
    s_sub_u32 s71, s37, s36
    s_cmp_lg_u32 s70, 0
    s_cselect_b32 s73, s36, s73
    s_cselect_b32 s74, s71, s74
    s_sub_u32 s62, s62, s63
    s_cmp_gt_u32 s49, s75
    s_cselect_b32 s63, 1, 0
    s_cmp_eq_u32 s62, 0
    s_cselect_b32 s70, s63, 0
    s_sub_u32 s71, s38, s37
    s_cmp_lg_u32 s70, 0
    s_cselect_b32 s73, s37, s73
    s_cselect_b32 s74, s71, s74
    s_sub_u32 s62, s62, s63
    s_cmp_gt_u32 s50, s75
    s_cselect_b32 s63, 1, 0
    s_cmp_eq_u32 s62, 0
    s_cselect_b32 s70, s63, 0
    s_sub_u32 s71, s39, s38
    s_cmp_lg_u32 s70, 0
    s_cselect_b32 s73, s38, s73
    s_cselect_b32 s74, s71, s74
    s_sub_u32 s62, s62, s63
    s_cmp_gt_u32 s51, s75
    s_cselect_b32 s63, 1, 0
    s_cmp_eq_u32 s62, 0
    s_cselect_b32 s70, s63, 0
    s_sub_u32 s71, s40, s39
    s_cmp_lg_u32 s70, 0
    s_cselect_b32 s73, s39, s73
    s_cselect_b32 s74, s71, s74
    s_sub_u32 s62, s62, s63
L_schd2:
    v_lshrrev_b32 v243, 5, v251
    v_and_b32 v244, 31, v251
    v_lshrrev_b32 v245, 2, v244
    v_mul_u32_u24 v224, 1040, v245
    v_and_b32 v246, 3, v251
    v_lshl_add_u32 v224, v246, 6, v224
    v_lshl_add_u32 v224, v243, 4, v224
    v_lshlrev_b32 v225, 10, v243
    v_bfe_u32 v245, v251, 2, 2
    v_lshl_add_u32 v225, v245, 6, v225
    v_bfe_u32 v245, v251, 4, 1
    v_lshl_add_u32 v225, v245, 5, v225
    v_lshl_add_u32 v225, v246, 3, v225
    v_bfe_u32 v245, v251, 2, 2
    v_lshlrev_b32 v226, 11, v245
    v_lshrrev_b32 v245, 4, v251
    v_lshl_add_u32 v226, v245, 6, v226
    v_lshl_add_u32 v226, v246, 4, v226
    v_add_u32 v227, 8192, v226
    v_add_u32 v228, 16384, v226
    v_add_u32 v229, 24576, v226
    v_lshlrev_b32 v230, 12, v244
    v_lshl_add_u32 v230, v243, 4, v230
    s_lshl_b32 s63, s43, 5
    v_add_u32 v231, s63, v244
    v_lshlrev_b32 v245, 2, v243
    v_sub_u32 v231, v231, v245
    v_mov_b32 v242, 0xff800000
    s_mul_i32 s59, s41, 4160
    s_mul_i32 s60, s41, 4096
L_item:
    s_lshl_b32 s62, s41, 4
    s_add_u32 s62, s62, s30
    s_lshl_b32 s62, s62, 11
    s_lshl_b32 s63, s26, 8
    s_add_u32 s52, s62, s63
    s_mov_b32 s57, s52
    s_mov_b32 s58, s52
    s_lshl_b32 s62, s28, 6
    s_lshl_b32 s63, s43, 5
    s_add_u32 s62, s62, s63
    s_add_u32 s70, s62, s30
    s_lshl_b32 s70, s70, 12
    s_lshl_b32 s71, s26, 1
    s_add_u32 s71, s71, s42
    s_lshl_b32 s71, s71, 8
    s_add_u32 s61, s70, s71
    s_sub_u32 s72, s29, 1
    s_cmp_lg_u32 s86, 0
    s_cbranch_scc1 L_item_noload
    buffer_load_dwordx4 v[160:163], v230, s[8:11], s61 offen offset:0
    buffer_load_dwordx4 v[164:167], v230, s[8:11], s61 offen offset:32
    buffer_load_dwordx4 v[168:171], v230, s[8:11], s61 offen offset:64
    buffer_load_dwordx4 v[172:175], v230, s[8:11], s61 offen offset:96
    buffer_load_dwordx4 v[176:179], v230, s[8:11], s61 offen offset:128
    buffer_load_dwordx4 v[180:183], v230, s[8:11], s61 offen offset:160
    buffer_load_dwordx4 v[184:187], v230, s[8:11], s61 offen offset:192
    buffer_load_dwordx4 v[188:191], v230, s[8:11], s61 offen offset:224
    s_add_u32 m0, s59, 0
    s_nop 0
    buffer_load_dwordx4 v226, s[12:15], s57 offen lds
    s_add_u32 m0, s59, 1040
    s_nop 0
    buffer_load_dwordx4 v227, s[12:15], s57 offen lds
    s_add_u32 m0, s59, 2080
    s_nop 0
    buffer_load_dwordx4 v228, s[12:15], s57 offen lds
    s_add_u32 m0, s59, 3120
    s_nop 0
    buffer_load_dwordx4 v229, s[12:15], s57 offen lds
L_item_noload:
    v_mov_b32 v232, 0xff800000
    v_mov_b32 v233, 0xff800000
    v_mov_b32 v234, 0xff800000
    v_mov_b32 v235, 0
    v_mov_b32 v236, 0
    v_mov_b32 v237, 1.0
    v_mov_b32 v0, 0
    v_mov_b32 v1, 0
    v_mov_b32 v2, 0
    v_mov_b32 v3, 0
    v_mov_b32 v4, 0
    v_mov_b32 v5, 0
    v_mov_b32 v6, 0
    v_mov_b32 v7, 0
    v_mov_b32 v8, 0
    v_mov_b32 v9, 0
    v_mov_b32 v10, 0
    v_mov_b32 v11, 0
    v_mov_b32 v12, 0
    v_mov_b32 v13, 0
    v_mov_b32 v14, 0
    v_mov_b32 v15, 0
    v_mov_b32 v16, 0
    v_mov_b32 v17, 0
    v_mov_b32 v18, 0
    v_mov_b32 v19, 0
    v_mov_b32 v20, 0
    v_mov_b32 v21, 0
    v_mov_b32 v22, 0
    v_mov_b32 v23, 0
    v_mov_b32 v24, 0
    v_mov_b32 v25, 0
    v_mov_b32 v26, 0
    v_mov_b32 v27, 0
    v_mov_b32 v28, 0
    v_mov_b32 v29, 0
    v_mov_b32 v30, 0
    v_mov_b32 v31, 0
    v_mov_b32 v32, 0
    v_mov_b32 v33, 0
    v_mov_b32 v34, 0
    v_mov_b32 v35, 0
    v_mov_b32 v36, 0
    v_mov_b32 v37, 0
    v_mov_b32 v38, 0
    v_mov_b32 v39, 0
    v_mov_b32 v40, 0
    v_mov_b32 v41, 0
    v_mov_b32 v42, 0
    v_mov_b32 v43, 0
    v_mov_b32 v44, 0
    v_mov_b32 v45, 0
    v_mov_b32 v46, 0
    v_mov_b32 v47, 0
    v_mov_b32 v48, 0
    v_mov_b32 v49, 0
    v_mov_b32 v50, 0
    v_mov_b32 v51, 0
    v_mov_b32 v52, 0
    v_mov_b32 v53, 0
    v_mov_b32 v54, 0
    v_mov_b32 v55, 0
    v_mov_b32 v56, 0
    v_mov_b32 v57, 0
    v_mov_b32 v58, 0
    v_mov_b32 v59, 0
    v_mov_b32 v60, 0
    v_mov_b32 v61, 0
    v_mov_b32 v62, 0
    v_mov_b32 v63, 0
    s_waitcnt vmcnt(0)
    s_barrier
L_pre:
    s_add_u32 s57, s57, 131072
    s_cmp_lt_u32 s72, 1
    s_cbranch_scc1 L_pre_nodma
    s_cmp_lg_u32 s86, 0
    s_cbranch_scc1 L_pre_nodma
    s_add_u32 m0, s59, 16640
    s_nop 0
    buffer_load_dwordx4 v226, s[12:15], s57 offen lds
    s_add_u32 m0, s59, 17680
    s_nop 0
    buffer_load_dwordx4 v227, s[12:15], s57 offen lds
    s_add_u32 m0, s59, 18720
    s_nop 0
    buffer_load_dwordx4 v228, s[12:15], s57 offen lds
    s_add_u32 m0, s59, 19760
    s_nop 0
    buffer_load_dwordx4 v229, s[12:15], s57 offen lds
L_pre_nodma:
    s_add_u32 s57, s57, 131072
    ds_read_b128 v[192:195], v224 offset:0
    ds_read_b128 v[196:199], v224 offset:32
    ds_read_b128 v[200:203], v224 offset:256
    s_waitcnt lgkmcnt(2)
    v_mfma_f32_32x32x16_bf16 v[64:79], v[192:195], v[160:163], 0
    ds_read_b128 v[204:207], v224 offset:288
    s_waitcnt lgkmcnt(2)
    v_mfma_f32_32x32x16_bf16 v[64:79], v[196:199], v[164:167], v[64:79]
    ds_read_b128 v[192:195], v224 offset:512
    s_waitcnt lgkmcnt(2)
    v_mfma_f32_32x32x16_bf16 v[64:79], v[200:203], v[168:171], v[64:79]
    ds_read_b128 v[196:199], v224 offset:544
    s_waitcnt lgkmcnt(2)
    v_mfma_f32_32x32x16_bf16 v[64:79], v[204:207], v[172:175], v[64:79]
    ds_read_b128 v[200:203], v224 offset:768
    s_waitcnt lgkmcnt(2)
    v_mfma_f32_32x32x16_bf16 v[64:79], v[192:195], v[176:179], v[64:79]
    ds_read_b128 v[204:207], v224 offset:800
    s_waitcnt lgkmcnt(2)
    v_mfma_f32_32x32x16_bf16 v[64:79], v[196:199], v[180:183], v[64:79]
    ds_read_b128 v[192:195], v224 offset:8320
    s_waitcnt lgkmcnt(2)
    v_mfma_f32_32x32x16_bf16 v[64:79], v[200:203], v[184:187], v[64:79]
    ds_read_b128 v[196:199], v224 offset:8352
    s_waitcnt lgkmcnt(2)
    v_mfma_f32_32x32x16_bf16 v[64:79], v[204:207], v[188:191], v[64:79]
    ds_read_b128 v[200:203], v224 offset:8576
    s_waitcnt lgkmcnt(2)
    v_mfma_f32_32x32x16_bf16 v[80:95], v[192:195], v[160:163], 0
    ds_read_b128 v[204:207], v224 offset:8608
    s_waitcnt lgkmcnt(2)
    v_mfma_f32_32x32x16_bf16 v[80:95], v[196:199], v[164:167], v[80:95]
    ds_read_b128 v[192:195], v224 offset:8832
    s_waitcnt lgkmcnt(2)
    v_mfma_f32_32x32x16_bf16 v[80:95], v[200:203], v[168:171], v[80:95]
    ds_read_b128 v[196:199], v224 offset:8864
    s_waitcnt lgkmcnt(2)
    v_mfma_f32_32x32x16_bf16 v[80:95], v[204:207], v[172:175], v[80:95]
    ds_read_b128 v[200:203], v224 offset:9088
    s_waitcnt lgkmcnt(2)
    v_mfma_f32_32x32x16_bf16 v[80:95], v[192:195], v[176:179], v[80:95]
    ds_read_b128 v[204:207], v224 offset:9120
    s_waitcnt lgkmcnt(2)
    v_mfma_f32_32x32x16_bf16 v[80:95], v[196:199], v[180:183], v[80:95]
    s_waitcnt lgkmcnt(1)
    v_mfma_f32_32x32x16_bf16 v[80:95], v[200:203], v[184:187], v[80:95]
    s_waitcnt lgkmcnt(0)
    v_mfma_f32_32x32x16_bf16 v[80:95], v[204:207], v[188:191], v[80:95]
    s_nop 15
    s_waitcnt vmcnt(0) lgkmcnt(0)
    s_barrier
    s_mov_b32 s55, 0
    s_cmp_eq_u32 s29, 1
    s_cbranch_scc1 L_only
L_first:
    s_add_u32 s62, s55, 2
    s_cmp_lt_u32 s62, s29
    s_cbranch_scc0 L_nokfirst
    s_add_u32 m0, s59, 0
    s_nop 0
    buffer_load_dwordx4 v226, s[12:15], s57 offen lds
    s_add_u32 m0, s59, 1040
    s_nop 0
    buffer_load_dwordx4 v227, s[12:15], s57 offen lds
    s_add_u32 m0, s59, 2080
    s_nop 0
    buffer_load_dwordx4 v228, s[12:15], s57 offen lds
    s_add_u32 m0, s59, 3120
    s_nop 0
    buffer_load_dwordx4 v229, s[12:15], s57 offen lds
L_nokfirst:
    s_add_u32 m0, s60, 33280
    s_nop 0
    buffer_load_dwordx4 v226, s[16:19], s58 offen lds
    s_add_u32 m0, s60, 34304
    s_nop 0
    buffer_load_dwordx4 v227, s[16:19], s58 offen lds
    s_add_u32 m0, s60, 35328
    s_nop 0
    buffer_load_dwordx4 v228, s[16:19], s58 offen lds
    s_add_u32 m0, s60, 36352
    s_nop 0
    buffer_load_dwordx4 v229, s[16:19], s58 offen lds
    s_add_u32 s57, s57, 131072
    s_add_u32 s58, s58, 131072
    ds_read_b128 v[192:195], v224 offset:16640
    ds_read_b128 v[196:199], v224 offset:16672
    ds_read_b128 v[200:203], v224 offset:16896
    v_max3_f32 v238, v64, v65, v66
    v_max3_f32 v238, v238, v67, v68
    v_max3_f32 v238, v238, v69, v70
    v_max_f32 v238, v238, v71
    v_max3_f32 v239, v72, v73, v74
    v_max3_f32 v239, v239, v75, v76
    v_max3_f32 v239, v239, v77, v78
    v_max_f32 v239, v239, v79
    v_max3_f32 v240, v80, v81, v82
    v_max3_f32 v240, v240, v83, v84
    s_waitcnt lgkmcnt(2)
    v_mfma_f32_32x32x16_bf16 v[96:111], v[192:195], v[160:163], 0
    ds_read_b128 v[204:207], v224 offset:16928
    v_max3_f32 v240, v240, v85, v86
    v_max_f32 v240, v240, v87
    v_max3_f32 v241, v88, v89, v90
    v_max3_f32 v241, v241, v91, v92
    v_max3_f32 v241, v241, v93, v94
    v_max_f32 v241, v241, v95
    v_max3_f32 v238, v238, v239, v240
    v_max_f32 v238, v238, v241
    s_waitcnt lgkmcnt(2)
    v_mfma_f32_32x32x16_bf16 v[96:111], v[196:199], v[164:167], v[96:111]
    ds_read_b128 v[192:195], v224 offset:17152
    v_mov_b32 v239, v238
    s_nop 1
    v_permlane32_swap_b32 v238, v239
    v_max_f32 v238, v238, v239
    v_cmp_gt_f32 vcc, v238, v234
    s_nop 0
    s_cbranch_vccnz L_rare3
L_back3:
    v_fma_f32 v64, v64, s53, -v233
    s_waitcnt lgkmcnt(2)
    v_mfma_f32_32x32x16_bf16 v[96:111], v[200:203], v[168:171], v[96:111]
    ds_read_b128 v[196:199], v224 offset:17184
    v_fma_f32 v65, v65, s53, -v233
    v_exp_f32 v64, v64
    v_fma_f32 v66, v66, s53, -v233
    v_exp_f32 v65, v65
    v_fma_f32 v67, v67, s53, -v233
    v_add_f32 v235, v235, v64
    v_exp_f32 v66, v66
    v_fma_f32 v68, v68, s53, -v233
    s_waitcnt lgkmcnt(2)
    v_mfma_f32_32x32x16_bf16 v[96:111], v[204:207], v[172:175], v[96:111]
    ds_read_b128 v[200:203], v224 offset:17408
    v_add_f32 v236, v236, v65
    v_cvt_pk_bf16_f32 v128, v64, v65
    v_exp_f32 v67, v67
    v_fma_f32 v69, v69, s53, -v233
    v_add_f32 v235, v235, v66
    v_exp_f32 v68, v68
    v_fma_f32 v70, v70, s53, -v233
    v_add_f32 v236, v236, v67
    s_waitcnt lgkmcnt(2)
    v_mfma_f32_32x32x16_bf16 v[96:111], v[192:195], v[176:179], v[96:111]
    ds_read_b128 v[204:207], v224 offset:17440
    v_cvt_pk_bf16_f32 v129, v66, v67
    v_exp_f32 v69, v69
    v_fma_f32 v71, v71, s53, -v233
    v_add_f32 v235, v235, v68
    v_exp_f32 v70, v70
    v_fma_f32 v72, v72, s53, -v233
    v_add_f32 v236, v236, v69
    v_cvt_pk_bf16_f32 v130, v68, v69
    s_waitcnt lgkmcnt(2)
    v_mfma_f32_32x32x16_bf16 v[96:111], v[196:199], v[180:183], v[96:111]
    ds_read_b128 v[192:195], v224 offset:24960
    v_exp_f32 v71, v71
    v_fma_f32 v73, v73, s53, -v233
    v_add_f32 v235, v235, v70
    v_exp_f32 v72, v72
    v_fma_f32 v74, v74, s53, -v233
    v_add_f32 v236, v236, v71
    v_cvt_pk_bf16_f32 v131, v70, v71
    v_exp_f32 v73, v73
    s_waitcnt lgkmcnt(2)
    v_mfma_f32_32x32x16_bf16 v[96:111], v[200:203], v[184:187], v[96:111]
    ds_read_b128 v[196:199], v224 offset:24992
    v_fma_f32 v75, v75, s53, -v233
    v_add_f32 v235, v235, v72
    v_exp_f32 v74, v74
    v_fma_f32 v76, v76, s53, -v233
    v_add_f32 v236, v236, v73
    v_cvt_pk_bf16_f32 v132, v72, v73
    v_exp_f32 v75, v75
    v_fma_f32 v77, v77, s53, -v233
    s_waitcnt lgkmcnt(2)
    v_mfma_f32_32x32x16_bf16 v[96:111], v[204:207], v[188:191], v[96:111]
    ds_read_b128 v[200:203], v224 offset:25216
    v_add_f32 v235, v235, v74
    v_exp_f32 v76, v76
    v_fma_f32 v78, v78, s53, -v233
    v_add_f32 v236, v236, v75
    v_cvt_pk_bf16_f32 v133, v74, v75
    v_exp_f32 v77, v77
    v_fma_f32 v79, v79, s53, -v233
    v_add_f32 v235, v235, v76
    s_waitcnt lgkmcnt(2)
    v_mfma_f32_32x32x16_bf16 v[112:127], v[192:195], v[160:163], 0
    ds_read_b128 v[204:207], v224 offset:25248
    v_exp_f32 v78, v78
    v_fma_f32 v80, v80, s53, -v233
    v_add_f32 v236, v236, v77
    v_cvt_pk_bf16_f32 v134, v76, v77
    v_exp_f32 v79, v79
    v_fma_f32 v81, v81, s53, -v233
    v_add_f32 v235, v235, v78
    v_exp_f32 v80, v80
    s_waitcnt lgkmcnt(2)
    v_mfma_f32_32x32x16_bf16 v[112:127], v[196:199], v[164:167], v[112:127]
    ds_read_b128 v[192:195], v224 offset:25472
    v_fma_f32 v82, v82, s53, -v233
    v_add_f32 v236, v236, v79
    v_cvt_pk_bf16_f32 v135, v78, v79
    v_exp_f32 v81, v81
    v_fma_f32 v83, v83, s53, -v233
    v_add_f32 v235, v235, v80
    v_exp_f32 v82, v82
    v_fma_f32 v84, v84, s53, -v233
    s_waitcnt lgkmcnt(2)
    v_mfma_f32_32x32x16_bf16 v[112:127], v[200:203], v[168:171], v[112:127]
    ds_read_b128 v[196:199], v224 offset:25504
    v_add_f32 v236, v236, v81
    v_cvt_pk_bf16_f32 v136, v80, v81
    v_exp_f32 v83, v83
    v_fma_f32 v85, v85, s53, -v233
    v_add_f32 v235, v235, v82
    v_exp_f32 v84, v84
    v_fma_f32 v86, v86, s53, -v233
    v_add_f32 v236, v236, v83
    s_waitcnt lgkmcnt(2)
    v_mfma_f32_32x32x16_bf16 v[112:127], v[204:207], v[172:175], v[112:127]
    ds_read_b128 v[200:203], v224 offset:25728
    v_cvt_pk_bf16_f32 v137, v82, v83
    v_exp_f32 v85, v85
    v_fma_f32 v87, v87, s53, -v233
    v_add_f32 v235, v235, v84
    v_exp_f32 v86, v86
    v_fma_f32 v88, v88, s53, -v233
    v_add_f32 v236, v236, v85
    v_cvt_pk_bf16_f32 v138, v84, v85
    s_waitcnt lgkmcnt(2)
    v_mfma_f32_32x32x16_bf16 v[112:127], v[192:195], v[176:179], v[112:127]
    ds_read_b128 v[204:207], v224 offset:25760
    v_exp_f32 v87, v87
    v_fma_f32 v89, v89, s53, -v233
    v_add_f32 v235, v235, v86
    v_exp_f32 v88, v88
    v_fma_f32 v90, v90, s53, -v233
    v_add_f32 v236, v236, v87
    v_cvt_pk_bf16_f32 v139, v86, v87
    v_exp_f32 v89, v89
    s_waitcnt lgkmcnt(2)
    v_mfma_f32_32x32x16_bf16 v[112:127], v[196:199], v[180:183], v[112:127]
    v_fma_f32 v91, v91, s53, -v233
    v_add_f32 v235, v235, v88
    v_exp_f32 v90, v90
    v_fma_f32 v92, v92, s53, -v233
    v_add_f32 v236, v236, v89
    v_cvt_pk_bf16_f32 v140, v88, v89
    v_exp_f32 v91, v91
    v_fma_f32 v93, v93, s53, -v233
    s_waitcnt lgkmcnt(1)
    v_mfma_f32_32x32x16_bf16 v[112:127], v[200:203], v[184:187], v[112:127]
    v_add_f32 v235, v235, v90
    v_exp_f32 v92, v92
    v_fma_f32 v94, v94, s53, -v233
    v_add_f32 v236, v236, v91
    v_cvt_pk_bf16_f32 v141, v90, v91
    v_exp_f32 v93, v93
    v_fma_f32 v95, v95, s53, -v233
    v_add_f32 v235, v235, v92
    s_waitcnt lgkmcnt(0)
    v_mfma_f32_32x32x16_bf16 v[112:127], v[204:207], v[188:191], v[112:127]
    v_exp_f32 v94, v94
    v_add_f32 v236, v236, v93
    v_cvt_pk_bf16_f32 v142, v92, v93
    v_exp_f32 v95, v95
    v_add_f32 v235, v235, v94
    v_add_f32 v236, v236, v95
    v_cvt_pk_bf16_f32 v143, v94, v95
    s_cmp_lg_u32 s56, 0
    s_cbranch_scc1 L_resc4
L_rback4:
    s_nop 15
    s_waitcnt vmcnt(0) lgkmcnt(0)
    s_barrier
    s_mov_b32 s55, 1
    s_cmp_eq_u32 s72, 1
    s_cbranch_scc1 L_last1
L_mid1:
    s_add_u32 s62, s55, 2
    s_cmp_lt_u32 s62, s29
    s_cbranch_scc0 L_nokmid1
    s_add_u32 m0, s59, 16640
    s_nop 0
    buffer_load_dwordx4 v226, s[12:15], s57 offen lds
    s_add_u32 m0, s59, 17680
    s_nop 0
    buffer_load_dwordx4 v227, s[12:15], s57 offen lds
    s_add_u32 m0, s59, 18720
    s_nop 0
    buffer_load_dwordx4 v228, s[12:15], s57 offen lds
    s_add_u32 m0, s59, 19760
    s_nop 0
    buffer_load_dwordx4 v229, s[12:15], s57 offen lds
L_nokmid1:
    s_add_u32 m0, s60, 49664
    s_nop 0
    buffer_load_dwordx4 v226, s[16:19], s58 offen lds
    s_add_u32 m0, s60, 50688
    s_nop 0
    buffer_load_dwordx4 v227, s[16:19], s58 offen lds
    s_add_u32 m0, s60, 51712
    s_nop 0
    buffer_load_dwordx4 v228, s[16:19], s58 offen lds
    s_add_u32 m0, s60, 52736
    s_nop 0
    buffer_load_dwordx4 v229, s[16:19], s58 offen lds
    s_add_u32 s57, s57, 131072
    s_add_u32 s58, s58, 131072
    ds_read_b128 v[192:195], v224 offset:0
    ds_read_b128 v[196:199], v224 offset:32
    ds_read_b128 v[200:203], v224 offset:256
    v_max3_f32 v238, v96, v97, v98
    v_max3_f32 v238, v238, v99, v100
    v_max3_f32 v238, v238, v101, v102
    v_max_f32 v238, v238, v103
    v_max3_f32 v239, v104, v105, v106
    v_max3_f32 v239, v239, v107, v108
    v_max3_f32 v239, v239, v109, v110
    v_max_f32 v239, v239, v111
    v_max3_f32 v240, v112, v113, v114
    v_max3_f32 v240, v240, v115, v116
    s_waitcnt lgkmcnt(2)
    v_mfma_f32_32x32x16_bf16 v[64:79], v[192:195], v[160:163], 0
    ds_read_b128 v[204:207], v224 offset:288
    v_max3_f32 v240, v240, v117, v118
    v_max_f32 v240, v240, v119
    v_max3_f32 v241, v120, v121, v122
    v_max3_f32 v241, v241, v123, v124
    s_waitcnt lgkmcnt(2)
    v_mfma_f32_32x32x16_bf16 v[64:79], v[196:199], v[164:167], v[64:79]
    ds_read_b128 v[192:195], v224 offset:512
    v_max3_f32 v241, v241, v125, v126
    v_max_f32 v241, v241, v127
    v_max3_f32 v238, v238, v239, v240
    v_max_f32 v238, v238, v241
    s_waitcnt lgkmcnt(2)
    v_mfma_f32_32x32x16_bf16 v[64:79], v[200:203], v[168:171], v[64:79]
    ds_read_b128 v[196:199], v224 offset:544
    v_mov_b32 v239, v238
    s_nop 1
    v_permlane32_swap_b32 v238, v239
    v_max_f32 v238, v238, v239
    s_waitcnt lgkmcnt(2)
    v_mfma_f32_32x32x16_bf16 v[64:79], v[204:207], v[172:175], v[64:79]
    ds_read_b128 v[200:203], v224 offset:768
    v_cmp_gt_f32 vcc, v238, v234
    s_nop 0
    s_cbranch_vccnz L_rare5
L_back5:
    v_fma_f32 v96, v96, s53, -v233
    s_waitcnt lgkmcnt(2)
    v_mfma_f32_32x32x16_bf16 v[64:79], v[192:195], v[176:179], v[64:79]
    ds_read_b128 v[204:207], v224 offset:800
    v_fma_f32 v97, v97, s53, -v233
    v_exp_f32 v96, v96
    v_fma_f32 v98, v98, s53, -v233
    v_exp_f32 v97, v97
    s_waitcnt lgkmcnt(2)
    v_mfma_f32_32x32x16_bf16 v[64:79], v[196:199], v[180:183], v[64:79]
    ds_read_b128 v[192:195], v224 offset:8320
    v_fma_f32 v99, v99, s53, -v233
    v_add_f32 v235, v235, v96
    v_exp_f32 v98, v98
    v_fma_f32 v100, v100, s53, -v233
    s_waitcnt lgkmcnt(2)
    v_mfma_f32_32x32x16_bf16 v[64:79], v[200:203], v[184:187], v[64:79]
    ds_read_b128 v[196:199], v224 offset:8352
    v_add_f32 v236, v236, v97
    v_cvt_pk_bf16_f32 v144, v96, v97
    v_exp_f32 v99, v99
    v_fma_f32 v101, v101, s53, -v233
    s_waitcnt lgkmcnt(2)
    v_mfma_f32_32x32x16_bf16 v[64:79], v[204:207], v[188:191], v[64:79]
    ds_read_b128 v[200:203], v224 offset:8576
    v_add_f32 v235, v235, v98
    v_exp_f32 v100, v100
    v_fma_f32 v102, v102, s53, -v233
    v_add_f32 v236, v236, v99
    s_waitcnt lgkmcnt(2)
    v_mfma_f32_32x32x16_bf16 v[80:95], v[192:195], v[160:163], 0
    ds_read_b128 v[204:207], v224 offset:8608
    v_cvt_pk_bf16_f32 v145, v98, v99
    v_exp_f32 v101, v101
    v_fma_f32 v103, v103, s53, -v233
    v_add_f32 v235, v235, v100
    s_waitcnt lgkmcnt(2)
    v_mfma_f32_32x32x16_bf16 v[80:95], v[196:199], v[164:167], v[80:95]
    ds_read_b128 v[192:195], v224 offset:8832
    v_exp_f32 v102, v102
    v_fma_f32 v104, v104, s53, -v233
    v_add_f32 v236, v236, v101
    v_cvt_pk_bf16_f32 v146, v100, v101
    s_waitcnt lgkmcnt(2)
    v_mfma_f32_32x32x16_bf16 v[80:95], v[200:203], v[168:171], v[80:95]
    ds_read_b128 v[196:199], v224 offset:8864
    v_exp_f32 v103, v103
    v_fma_f32 v105, v105, s53, -v233
    v_add_f32 v235, v235, v102
    v_exp_f32 v104, v104
    s_waitcnt lgkmcnt(2)
    v_mfma_f32_32x32x16_bf16 v[80:95], v[204:207], v[172:175], v[80:95]
    ds_read_b128 v[200:203], v224 offset:9088
    v_fma_f32 v106, v106, s53, -v233
    v_add_f32 v236, v236, v103
    v_cvt_pk_bf16_f32 v147, v102, v103
    v_exp_f32 v105, v105
    s_waitcnt lgkmcnt(2)
    v_mfma_f32_32x32x16_bf16 v[80:95], v[192:195], v[176:179], v[80:95]
    ds_read_b128 v[204:207], v224 offset:9120
    v_fma_f32 v107, v107, s53, -v233
    v_add_f32 v235, v235, v104
    v_exp_f32 v106, v106
    v_fma_f32 v108, v108, s53, -v233
    s_waitcnt lgkmcnt(2)
    v_mfma_f32_32x32x16_bf16 v[80:95], v[196:199], v[180:183], v[80:95]
    ds_read_b64_tr_b16 v[208:209], v225 offset:33280
    ds_read_b64_tr_b16 v[210:211], v225 offset:35328
    v_add_f32 v236, v236, v105
    v_cvt_pk_bf16_f32 v148, v104, v105
    v_exp_f32 v107, v107
    v_fma_f32 v109, v109, s53, -v233
    s_waitcnt lgkmcnt(3)
    v_mfma_f32_32x32x16_bf16 v[80:95], v[200:203], v[184:187], v[80:95]
    ds_read_b64_tr_b16 v[212:213], v225 offset:33536
    ds_read_b64_tr_b16 v[214:215], v225 offset:35584
    v_add_f32 v235, v235, v106
    v_exp_f32 v108, v108
    v_fma_f32 v110, v110, s53, -v233
    v_add_f32 v236, v236, v107
    s_waitcnt lgkmcnt(4)
    v_mfma_f32_32x32x16_bf16 v[80:95], v[204:207], v[188:191], v[80:95]
    ds_read_b64_tr_b16 v[216:217], v225 offset:33792
    ds_read_b64_tr_b16 v[218:219], v225 offset:35840
    v_cvt_pk_bf16_f32 v149, v106, v107
    v_exp_f32 v109, v109
    v_fma_f32 v111, v111, s53, -v233
    v_add_f32 v235, v235, v108
    s_waitcnt lgkmcnt(4)
    v_mfma_f32_32x32x16_bf16 v[0:15], v[208:211], v[128:131], v[0:15]
    ds_read_b64_tr_b16 v[220:221], v225 offset:34048
    ds_read_b64_tr_b16 v[222:223], v225 offset:36096
    v_exp_f32 v110, v110
    v_fma_f32 v112, v112, s53, -v233
    v_add_f32 v236, v236, v109
    v_cvt_pk_bf16_f32 v150, v108, v109
    s_waitcnt lgkmcnt(4)
    v_mfma_f32_32x32x16_bf16 v[16:31], v[212:215], v[128:131], v[16:31]
    ds_read_b64_tr_b16 v[208:209], v225 offset:37376
    ds_read_b64_tr_b16 v[210:211], v225 offset:39424
    v_exp_f32 v111, v111
    v_fma_f32 v113, v113, s53, -v233
    v_add_f32 v235, v235, v110
    v_exp_f32 v112, v112
    s_waitcnt lgkmcnt(4)
    v_mfma_f32_32x32x16_bf16 v[32:47], v[216:219], v[128:131], v[32:47]
    ds_read_b64_tr_b16 v[212:213], v225 offset:37632
    ds_read_b64_tr_b16 v[214:215], v225 offset:39680
    v_fma_f32 v114, v114, s53, -v233
    v_add_f32 v236, v236, v111
    v_cvt_pk_bf16_f32 v151, v110, v111
    v_exp_f32 v113, v113
    s_waitcnt lgkmcnt(4)
    v_mfma_f32_32x32x16_bf16 v[48:63], v[220:223], v[128:131], v[48:63]
    ds_read_b64_tr_b16 v[216:217], v225 offset:37888
    ds_read_b64_tr_b16 v[218:219], v225 offset:39936
    v_fma_f32 v115, v115, s53, -v233
    v_add_f32 v235, v235, v112
    v_exp_f32 v114, v114
    v_fma_f32 v116, v116, s53, -v233
    s_waitcnt lgkmcnt(4)
    v_mfma_f32_32x32x16_bf16 v[0:15], v[208:211], v[132:135], v[0:15]
    ds_read_b64_tr_b16 v[220:221], v225 offset:38144
    ds_read_b64_tr_b16 v[222:223], v225 offset:40192
    v_add_f32 v236, v236, v113
    v_cvt_pk_bf16_f32 v152, v112, v113
    v_exp_f32 v115, v115
    v_fma_f32 v117, v117, s53, -v233
    s_waitcnt lgkmcnt(4)
    v_mfma_f32_32x32x16_bf16 v[16:31], v[212:215], v[132:135], v[16:31]
    ds_read_b64_tr_b16 v[208:209], v225 offset:41472
    ds_read_b64_tr_b16 v[210:211], v225 offset:43520
    v_add_f32 v235, v235, v114
    v_exp_f32 v116, v116
    v_fma_f32 v118, v118, s53, -v233
    v_add_f32 v236, v236, v115
    s_waitcnt lgkmcnt(4)
    v_mfma_f32_32x32x16_bf16 v[32:47], v[216:219], v[132:135], v[32:47]
    ds_read_b64_tr_b16 v[212:213], v225 offset:41728
    ds_read_b64_tr_b16 v[214:215], v225 offset:43776
    v_cvt_pk_bf16_f32 v153, v114, v115
    v_exp_f32 v117, v117
    v_fma_f32 v119, v119, s53, -v233
    v_add_f32 v235, v235, v116
    s_waitcnt lgkmcnt(4)
    v_mfma_f32_32x32x16_bf16 v[48:63], v[220:223], v[132:135], v[48:63]
    ds_read_b64_tr_b16 v[216:217], v225 offset:41984
    ds_read_b64_tr_b16 v[218:219], v225 offset:44032
    v_exp_f32 v118, v118
    v_fma_f32 v120, v120, s53, -v233
    v_add_f32 v236, v236, v117
    v_cvt_pk_bf16_f32 v154, v116, v117
    s_waitcnt lgkmcnt(4)
    v_mfma_f32_32x32x16_bf16 v[0:15], v[208:211], v[136:139], v[0:15]
    ds_read_b64_tr_b16 v[220:221], v225 offset:42240
    ds_read_b64_tr_b16 v[222:223], v225 offset:44288
    v_exp_f32 v119, v119
    v_fma_f32 v121, v121, s53, -v233
    v_add_f32 v235, v235, v118
    v_exp_f32 v120, v120
    s_waitcnt lgkmcnt(4)
    v_mfma_f32_32x32x16_bf16 v[16:31], v[212:215], v[136:139], v[16:31]
    ds_read_b64_tr_b16 v[208:209], v225 offset:45568
    ds_read_b64_tr_b16 v[210:211], v225 offset:47616
    v_fma_f32 v122, v122, s53, -v233
    v_add_f32 v236, v236, v119
    v_cvt_pk_bf16_f32 v155, v118, v119
    v_exp_f32 v121, v121
    s_waitcnt lgkmcnt(4)
    v_mfma_f32_32x32x16_bf16 v[32:47], v[216:219], v[136:139], v[32:47]
    ds_read_b64_tr_b16 v[212:213], v225 offset:45824
    ds_read_b64_tr_b16 v[214:215], v225 offset:47872
    v_fma_f32 v123, v123, s53, -v233
    v_add_f32 v235, v235, v120
    v_exp_f32 v122, v122
    v_fma_f32 v124, v124, s53, -v233
    s_waitcnt lgkmcnt(4)
    v_mfma_f32_32x32x16_bf16 v[48:63], v[220:223], v[136:139], v[48:63]
    ds_read_b64_tr_b16 v[216:217], v225 offset:46080
    ds_read_b64_tr_b16 v[218:219], v225 offset:48128
    v_add_f32 v236, v236, v121
    v_cvt_pk_bf16_f32 v156, v120, v121
    v_exp_f32 v123, v123
    v_fma_f32 v125, v125, s53, -v233
    s_waitcnt lgkmcnt(4)
    v_mfma_f32_32x32x16_bf16 v[0:15], v[208:211], v[140:143], v[0:15]
    ds_read_b64_tr_b16 v[220:221], v225 offset:46336
    ds_read_b64_tr_b16 v[222:223], v225 offset:48384
    v_add_f32 v235, v235, v122
    v_exp_f32 v124, v124
    v_fma_f32 v126, v126, s53, -v233
    v_add_f32 v236, v236, v123
    s_waitcnt lgkmcnt(4)
    v_mfma_f32_32x32x16_bf16 v[16:31], v[212:215], v[140:143], v[16:31]
    v_cvt_pk_bf16_f32 v157, v122, v123
    v_exp_f32 v125, v125
    v_fma_f32 v127, v127, s53, -v233
    v_add_f32 v235, v235, v124
    s_waitcnt lgkmcnt(2)
    v_mfma_f32_32x32x16_bf16 v[32:47], v[216:219], v[140:143], v[32:47]
    v_exp_f32 v126, v126
    v_add_f32 v236, v236, v125
    v_cvt_pk_bf16_f32 v158, v124, v125
    v_exp_f32 v127, v127
    s_waitcnt lgkmcnt(0)
    v_mfma_f32_32x32x16_bf16 v[48:63], v[220:223], v[140:143], v[48:63]
    v_add_f32 v235, v235, v126
    v_add_f32 v236, v236, v127
    v_cvt_pk_bf16_f32 v159, v126, v127
    s_cmp_lg_u32 s56, 0
    s_cbranch_scc1 L_resc6
L_rback6:
    s_waitcnt vmcnt(0) lgkmcnt(0)
    s_barrier
    s_add_u32 s55, s55, 1
    s_cmp_eq_u32 s55, s72
    s_cbranch_scc1 L_last0
L_mid0:
    s_add_u32 s62, s55, 2
    s_cmp_lt_u32 s62, s29
    s_cbranch_scc0 L_nokmid0
    s_add_u32 m0, s59, 0
    s_nop 0
    buffer_load_dwordx4 v226, s[12:15], s57 offen lds
    s_add_u32 m0, s59, 1040
    s_nop 0
    buffer_load_dwordx4 v227, s[12:15], s57 offen lds
    s_add_u32 m0, s59, 2080
    s_nop 0
    buffer_load_dwordx4 v228, s[12:15], s57 offen lds
    s_add_u32 m0, s59, 3120
    s_nop 0
    buffer_load_dwordx4 v229, s[12:15], s57 offen lds
L_nokmid0:
    s_add_u32 m0, s60, 33280
    s_nop 0
    buffer_load_dwordx4 v226, s[16:19], s58 offen lds
    s_add_u32 m0, s60, 34304
    s_nop 0
    buffer_load_dwordx4 v227, s[16:19], s58 offen lds
    s_add_u32 m0, s60, 35328
    s_nop 0
    buffer_load_dwordx4 v228, s[16:19], s58 offen lds
    s_add_u32 m0, s60, 36352
    s_nop 0
    buffer_load_dwordx4 v229, s[16:19], s58 offen lds
    s_add_u32 s57, s57, 131072
    s_add_u32 s58, s58, 131072
    ds_read_b128 v[192:195], v224 offset:16640
    ds_read_b128 v[196:199], v224 offset:16672
    ds_read_b128 v[200:203], v224 offset:16896
    v_max3_f32 v238, v64, v65, v66
    v_max3_f32 v238, v238, v67, v68
    v_max3_f32 v238, v238, v69, v70
    v_max_f32 v238, v238, v71
    v_max3_f32 v239, v72, v73, v74
    v_max3_f32 v239, v239, v75, v76
    v_max3_f32 v239, v239, v77, v78
    v_max_f32 v239, v239, v79
    v_max3_f32 v240, v80, v81, v82
    v_max3_f32 v240, v240, v83, v84
    s_waitcnt lgkmcnt(2)
    v_mfma_f32_32x32x16_bf16 v[96:111], v[192:195], v[160:163], 0
    ds_read_b128 v[204:207], v224 offset:16928
    v_max3_f32 v240, v240, v85, v86
    v_max_f32 v240, v240, v87
    v_max3_f32 v241, v88, v89, v90
    v_max3_f32 v241, v241, v91, v92
    s_waitcnt lgkmcnt(2)
    v_mfma_f32_32x32x16_bf16 v[96:111], v[196:199], v[164:167], v[96:111]
    ds_read_b128 v[192:195], v224 offset:17152
    v_max3_f32 v241, v241, v93, v94
    v_max_f32 v241, v241, v95
    v_max3_f32 v238, v238, v239, v240
    v_max_f32 v238, v238, v241
    s_waitcnt lgkmcnt(2)
    v_mfma_f32_32x32x16_bf16 v[96:111], v[200:203], v[168:171], v[96:111]
    ds_read_b128 v[196:199], v224 offset:17184
    v_mov_b32 v239, v238
    s_nop 1
    v_permlane32_swap_b32 v238, v239
    v_max_f32 v238, v238, v239
    s_waitcnt lgkmcnt(2)
    v_mfma_f32_32x32x16_bf16 v[96:111], v[204:207], v[172:175], v[96:111]
    ds_read_b128 v[200:203], v224 offset:17408
    v_cmp_gt_f32 vcc, v238, v234
    s_nop 0
    s_cbranch_vccnz L_rare7
L_back7:
    v_fma_f32 v64, v64, s53, -v233
    s_waitcnt lgkmcnt(2)
    v_mfma_f32_32x32x16_bf16 v[96:111], v[192:195], v[176:179], v[96:111]
    ds_read_b128 v[204:207], v224 offset:17440
    v_fma_f32 v65, v65, s53, -v233
    v_exp_f32 v64, v64
    v_fma_f32 v66, v66, s53, -v233
    v_exp_f32 v65, v65
    s_waitcnt lgkmcnt(2)
    v_mfma_f32_32x32x16_bf16 v[96:111], v[196:199], v[180:183], v[96:111]
    ds_read_b128 v[192:195], v224 offset:24960
    v_fma_f32 v67, v67, s53, -v233
    v_add_f32 v235, v235, v64
    v_exp_f32 v66, v66
    v_fma_f32 v68, v68, s53, -v233
    s_waitcnt lgkmcnt(2)
    v_mfma_f32_32x32x16_bf16 v[96:111], v[200:203], v[184:187], v[96:111]
    ds_read_b128 v[196:199], v224 offset:24992
    v_add_f32 v236, v236, v65
    v_cvt_pk_bf16_f32 v128, v64, v65
    v_exp_f32 v67, v67
    v_fma_f32 v69, v69, s53, -v233
    s_waitcnt lgkmcnt(2)
    v_mfma_f32_32x32x16_bf16 v[96:111], v[204:207], v[188:191], v[96:111]
    ds_read_b128 v[200:203], v224 offset:25216
    v_add_f32 v235, v235, v66
    v_exp_f32 v68, v68
    v_fma_f32 v70, v70, s53, -v233
    v_add_f32 v236, v236, v67
    s_waitcnt lgkmcnt(2)
    v_mfma_f32_32x32x16_bf16 v[112:127], v[192:195], v[160:163], 0
    ds_read_b128 v[204:207], v224 offset:25248
    v_cvt_pk_bf16_f32 v129, v66, v67
    v_exp_f32 v69, v69
    v_fma_f32 v71, v71, s53, -v233
    v_add_f32 v235, v235, v68
    s_waitcnt lgkmcnt(2)
    v_mfma_f32_32x32x16_bf16 v[112:127], v[196:199], v[164:167], v[112:127]
    ds_read_b128 v[192:195], v224 offset:25472
    v_exp_f32 v70, v70
    v_fma_f32 v72, v72, s53, -v233
    v_add_f32 v236, v236, v69
    v_cvt_pk_bf16_f32 v130, v68, v69
    s_waitcnt lgkmcnt(2)
    v_mfma_f32_32x32x16_bf16 v[112:127], v[200:203], v[168:171], v[112:127]
    ds_read_b128 v[196:199], v224 offset:25504
    v_exp_f32 v71, v71
    v_fma_f32 v73, v73, s53, -v233
    v_add_f32 v235, v235, v70
    v_exp_f32 v72, v72
    s_waitcnt lgkmcnt(2)
    v_mfma_f32_32x32x16_bf16 v[112:127], v[204:207], v[172:175], v[112:127]
    ds_read_b128 v[200:203], v224 offset:25728
    v_fma_f32 v74, v74, s53, -v233
    v_add_f32 v236, v236, v71
    v_cvt_pk_bf16_f32 v131, v70, v71
    v_exp_f32 v73, v73
    s_waitcnt lgkmcnt(2)
    v_mfma_f32_32x32x16_bf16 v[112:127], v[192:195], v[176:179], v[112:127]
    ds_read_b128 v[204:207], v224 offset:25760
    v_fma_f32 v75, v75, s53, -v233
    v_add_f32 v235, v235, v72
    v_exp_f32 v74, v74
    v_fma_f32 v76, v76, s53, -v233
    s_waitcnt lgkmcnt(2)
    v_mfma_f32_32x32x16_bf16 v[112:127], v[196:199], v[180:183], v[112:127]
    ds_read_b64_tr_b16 v[208:209], v225 offset:49664
    ds_read_b64_tr_b16 v[210:211], v225 offset:51712
    v_add_f32 v236, v236, v73
    v_cvt_pk_bf16_f32 v132, v72, v73
    v_exp_f32 v75, v75
    v_fma_f32 v77, v77, s53, -v233
    s_waitcnt lgkmcnt(3)
    v_mfma_f32_32x32x16_bf16 v[112:127], v[200:203], v[184:187], v[112:127]
    ds_read_b64_tr_b16 v[212:213], v225 offset:49920
    ds_read_b64_tr_b16 v[214:215], v225 offset:51968
    v_add_f32 v235, v235, v74
    v_exp_f32 v76, v76
    v_fma_f32 v78, v78, s53, -v233
    v_add_f32 v236, v236, v75
    s_waitcnt lgkmcnt(4)
    v_mfma_f32_32x32x16_bf16 v[112:127], v[204:207], v[188:191], v[112:127]
    ds_read_b64_tr_b16 v[216:217], v225 offset:50176
    ds_read_b64_tr_b16 v[218:219], v225 offset:52224
    v_cvt_pk_bf16_f32 v133, v74, v75
    v_exp_f32 v77, v77
    v_fma_f32 v79, v79, s53, -v233
    v_add_f32 v235, v235, v76
    s_waitcnt lgkmcnt(4)
    v_mfma_f32_32x32x16_bf16 v[0:15], v[208:211], v[144:147], v[0:15]
    ds_read_b64_tr_b16 v[220:221], v225 offset:50432
    ds_read_b64_tr_b16 v[222:223], v225 offset:52480
    v_exp_f32 v78, v78
    v_fma_f32 v80, v80, s53, -v233
    v_add_f32 v236, v236, v77
    v_cvt_pk_bf16_f32 v134, v76, v77
    s_waitcnt lgkmcnt(4)
    v_mfma_f32_32x32x16_bf16 v[16:31], v[212:215], v[144:147], v[16:31]
    ds_read_b64_tr_b16 v[208:209], v225 offset:53760
    ds_read_b64_tr_b16 v[210:211], v225 offset:55808
    v_exp_f32 v79, v79
    v_fma_f32 v81, v81, s53, -v233
    v_add_f32 v235, v235, v78
    v_exp_f32 v80, v80
    s_waitcnt lgkmcnt(4)
    v_mfma_f32_32x32x16_bf16 v[32:47], v[216:219], v[144:147], v[32:47]
    ds_read_b64_tr_b16 v[212:213], v225 offset:54016
    ds_read_b64_tr_b16 v[214:215], v225 offset:56064
    v_fma_f32 v82, v82, s53, -v233
    v_add_f32 v236, v236, v79
    v_cvt_pk_bf16_f32 v135, v78, v79
    v_exp_f32 v81, v81
    s_waitcnt lgkmcnt(4)
    v_mfma_f32_32x32x16_bf16 v[48:63], v[220:223], v[144:147], v[48:63]
    ds_read_b64_tr_b16 v[216:217], v225 offset:54272
    ds_read_b64_tr_b16 v[218:219], v225 offset:56320
    v_fma_f32 v83, v83, s53, -v233
    v_add_f32 v235, v235, v80
    v_exp_f32 v82, v82
    v_fma_f32 v84, v84, s53, -v233
    s_waitcnt lgkmcnt(4)
    v_mfma_f32_32x32x16_bf16 v[0:15], v[208:211], v[148:151], v[0:15]
    ds_read_b64_tr_b16 v[220:221], v225 offset:54528
    ds_read_b64_tr_b16 v[222:223], v225 offset:56576
    v_add_f32 v236, v236, v81
    v_cvt_pk_bf16_f32 v136, v80, v81
    v_exp_f32 v83, v83
    v_fma_f32 v85, v85, s53, -v233
    s_waitcnt lgkmcnt(4)
    v_mfma_f32_32x32x16_bf16 v[16:31], v[212:215], v[148:151], v[16:31]
    ds_read_b64_tr_b16 v[208:209], v225 offset:57856
    ds_read_b64_tr_b16 v[210:211], v225 offset:59904
    v_add_f32 v235, v235, v82
    v_exp_f32 v84, v84
    v_fma_f32 v86, v86, s53, -v233
    v_add_f32 v236, v236, v83
    s_waitcnt lgkmcnt(4)
    v_mfma_f32_32x32x16_bf16 v[32:47], v[216:219], v[148:151], v[32:47]
    ds_read_b64_tr_b16 v[212:213], v225 offset:58112
    ds_read_b64_tr_b16 v[214:215], v225 offset:60160
    v_cvt_pk_bf16_f32 v137, v82, v83
    v_exp_f32 v85, v85
    v_fma_f32 v87, v87, s53, -v233
    v_add_f32 v235, v235, v84
    s_waitcnt lgkmcnt(4)
    v_mfma_f32_32x32x16_bf16 v[48:63], v[220:223], v[148:151], v[48:63]
    ds_read_b64_tr_b16 v[216:217], v225 offset:58368
    ds_read_b64_tr_b16 v[218:219], v225 offset:60416
    v_exp_f32 v86, v86
    v_fma_f32 v88, v88, s53, -v233
    v_add_f32 v236, v236, v85
    v_cvt_pk_bf16_f32 v138, v84, v85
    s_waitcnt lgkmcnt(4)
    v_mfma_f32_32x32x16_bf16 v[0:15], v[208:211], v[152:155], v[0:15]
    ds_read_b64_tr_b16 v[220:221], v225 offset:58624
    ds_read_b64_tr_b16 v[222:223], v225 offset:60672
    v_exp_f32 v87, v87
    v_fma_f32 v89, v89, s53, -v233
    v_add_f32 v235, v235, v86
    v_exp_f32 v88, v88
    s_waitcnt lgkmcnt(4)
    v_mfma_f32_32x32x16_bf16 v[16:31], v[212:215], v[152:155], v[16:31]
    ds_read_b64_tr_b16 v[208:209], v225 offset:61952
    ds_read_b64_tr_b16 v[210:211], v225 offset:64000
    v_fma_f32 v90, v90, s53, -v233
    v_add_f32 v236, v236, v87
    v_cvt_pk_bf16_f32 v139, v86, v87
    v_exp_f32 v89, v89
    s_waitcnt lgkmcnt(4)
    v_mfma_f32_32x32x16_bf16 v[32:47], v[216:219], v[152:155], v[32:47]
    ds_read_b64_tr_b16 v[212:213], v225 offset:62208
    ds_read_b64_tr_b16 v[214:215], v225 offset:64256
    v_fma_f32 v91, v91, s53, -v233
    v_add_f32 v235, v235, v88
    v_exp_f32 v90, v90
    v_fma_f32 v92, v92, s53, -v233
    s_waitcnt lgkmcnt(4)
    v_mfma_f32_32x32x16_bf16 v[48:63], v[220:223], v[152:155], v[48:63]
    ds_read_b64_tr_b16 v[216:217], v225 offset:62464
    ds_read_b64_tr_b16 v[218:219], v225 offset:64512
    v_add_f32 v236, v236, v89
    v_cvt_pk_bf16_f32 v140, v88, v89
    v_exp_f32 v91, v91
    v_fma_f32 v93, v93, s53, -v233
    s_waitcnt lgkmcnt(4)
    v_mfma_f32_32x32x16_bf16 v[0:15], v[208:211], v[156:159], v[0:15]
    ds_read_b64_tr_b16 v[220:221], v225 offset:62720
    ds_read_b64_tr_b16 v[222:223], v225 offset:64768
    v_add_f32 v235, v235, v90
    v_exp_f32 v92, v92
    v_fma_f32 v94, v94, s53, -v233
    v_add_f32 v236, v236, v91
    s_waitcnt lgkmcnt(4)
    v_mfma_f32_32x32x16_bf16 v[16:31], v[212:215], v[156:159], v[16:31]
    v_cvt_pk_bf16_f32 v141, v90, v91
    v_exp_f32 v93, v93
    v_fma_f32 v95, v95, s53, -v233
    v_add_f32 v235, v235, v92
    s_waitcnt lgkmcnt(2)
    v_mfma_f32_32x32x16_bf16 v[32:47], v[216:219], v[156:159], v[32:47]
    v_exp_f32 v94, v94
    v_add_f32 v236, v236, v93
    v_cvt_pk_bf16_f32 v142, v92, v93
    v_exp_f32 v95, v95
    s_waitcnt lgkmcnt(0)
    v_mfma_f32_32x32x16_bf16 v[48:63], v[220:223], v[156:159], v[48:63]
    v_add_f32 v235, v235, v94
    v_add_f32 v236, v236, v95
    v_cvt_pk_bf16_f32 v143, v94, v95
    s_cmp_lg_u32 s56, 0
    s_cbranch_scc1 L_resc8
L_rback8:
    s_waitcnt vmcnt(0) lgkmcnt(0)
    s_barrier
    s_add_u32 s55, s55, 1
    s_cmp_eq_u32 s55, s72
    s_cbranch_scc1 L_last1
    s_branch L_mid1
L_last0:
    s_add_u32 m0, s60, 33280
    s_nop 0
    buffer_load_dwordx4 v226, s[16:19], s58 offen lds
    s_add_u32 m0, s60, 34304
    s_nop 0
    buffer_load_dwordx4 v227, s[16:19], s58 offen lds
    s_add_u32 m0, s60, 35328
    s_nop 0
    buffer_load_dwordx4 v228, s[16:19], s58 offen lds
    s_add_u32 m0, s60, 36352
    s_nop 0
    buffer_load_dwordx4 v229, s[16:19], s58 offen lds
    s_mov_b32 s85, 0
    s_cmp_eq_u32 s84, 0
    s_cbranch_scc1 L_nopflast0
    s_lshl_b32 s62, s41, 4
    s_add_u32 s62, s62, s73
    s_lshl_b32 s62, s62, 11
    s_lshl_b32 s63, s26, 8
    s_add_u32 s87, s62, s63
    s_lshl_b32 s62, s75, 6
    s_lshl_b32 s63, s43, 5
    s_add_u32 s62, s62, s63
    s_add_u32 s70, s62, s73
    s_lshl_b32 s70, s70, 12
    s_lshl_b32 s71, s26, 1
    s_add_u32 s71, s71, s42
    s_lshl_b32 s71, s71, 8
    s_add_u32 s88, s70, s71
    buffer_load_dwordx4 v[160:163], v230, s[8:11], s88 offen offset:0
    buffer_load_dwordx4 v[164:167], v230, s[8:11], s88 offen offset:32
    buffer_load_dwordx4 v[168:171], v230, s[8:11], s88 offen offset:64
    buffer_load_dwordx4 v[172:175], v230, s[8:11], s88 offen offset:96
    buffer_load_dwordx4 v[176:179], v230, s[8:11], s88 offen offset:128
    buffer_load_dwordx4 v[180:183], v230, s[8:11], s88 offen offset:160
    buffer_load_dwordx4 v[184:187], v230, s[8:11], s88 offen offset:192
    buffer_load_dwordx4 v[188:191], v230, s[8:11], s88 offen offset:224
    s_add_u32 m0, s59, 0
    s_nop 0
    buffer_load_dwordx4 v226, s[12:15], s87 offen lds
    s_add_u32 m0, s59, 1040
    s_nop 0
    buffer_load_dwordx4 v227, s[12:15], s87 offen lds
    s_add_u32 m0, s59, 2080
    s_nop 0
    buffer_load_dwordx4 v228, s[12:15], s87 offen lds
    s_add_u32 m0, s59, 3120
    s_nop 0
    buffer_load_dwordx4 v229, s[12:15], s87 offen lds
    s_mov_b32 s85, 12
    s_cmp_lt_u32 s84, 2
    s_cbranch_scc1 L_nopflast0
    s_add_u32 s87, s87, 131072
    s_add_u32 m0, s59, 16640
    s_nop 0
    buffer_load_dwordx4 v226, s[12:15], s87 offen lds
    s_add_u32 m0, s59, 17680
    s_nop 0
    buffer_load_dwordx4 v227, s[12:15], s87 offen lds
    s_add_u32 m0, s59, 18720
    s_nop 0
    buffer_load_dwordx4 v228, s[12:15], s87 offen lds
    s_add_u32 m0, s59, 19760
    s_nop 0
    buffer_load_dwordx4 v229, s[12:15], s87 offen lds
    s_mov_b32 s85, 16
L_nopflast0:
    ds_read_b64_tr_b16 v[208:209], v225 offset:49664
    ds_read_b64_tr_b16 v[210:211], v225 offset:51712
    ds_read_b64_tr_b16 v[212:213], v225 offset:49920
    ds_read_b64_tr_b16 v[214:215], v225 offset:51968
    ds_read_b64_tr_b16 v[216:217], v225 offset:50176
    ds_read_b64_tr_b16 v[218:219], v225 offset:52224
    v_cmp_gt_i32 s[64:65], 0, v231
    v_cmp_gt_i32 s[66:67], 1, v231
    v_cmp_gt_i32 s[68:69], 2, v231
    v_cndmask_b32 v64, v64, v242, s[64:65]
    v_cmp_gt_i32 s[64:65], 3, v231
    v_cndmask_b32 v65, v65, v242, s[66:67]
    v_cmp_gt_i32 s[66:67], 8, v231
    v_cndmask_b32 v66, v66, v242, s[68:69]
    v_cmp_gt_i32 s[68:69], 9, v231
    v_cndmask_b32 v67, v67, v242, s[64:65]
    s_waitcnt lgkmcnt(4)
    v_mfma_f32_32x32x16_bf16 v[0:15], v[208:211], v[144:147], v[0:15]
    ds_read_b64_tr_b16 v[220:221], v225 offset:50432
    ds_read_b64_tr_b16 v[222:223], v225 offset:52480
    v_cmp_gt_i32 s[64:65], 10, v231
    v_cndmask_b32 v68, v68, v242, s[66:67]
    v_cmp_gt_i32 s[66:67], 11, v231
    v_cndmask_b32 v69, v69, v242, s[68:69]
    v_cmp_gt_i32 s[68:69], 16, v231
    v_cndmask_b32 v70, v70, v242, s[64:65]
    v_cmp_gt_i32 s[64:65], 17, v231
    v_cndmask_b32 v71, v71, v242, s[66:67]
    v_cmp_gt_i32 s[66:67], 18, v231
    v_cndmask_b32 v72, v72, v242, s[68:69]
    v_cmp_gt_i32 s[68:69], 19, v231
    v_cndmask_b32 v73, v73, v242, s[64:65]
    s_waitcnt lgkmcnt(4)
    v_mfma_f32_32x32x16_bf16 v[16:31], v[212:215], v[144:147], v[16:31]
    ds_read_b64_tr_b16 v[208:209], v225 offset:53760
    ds_read_b64_tr_b16 v[210:211], v225 offset:55808
    v_cmp_gt_i32 s[64:65], 24, v231
    v_cndmask_b32 v74, v74, v242, s[66:67]
    v_cmp_gt_i32 s[66:67], 25, v231
    v_cndmask_b32 v75, v75, v242, s[68:69]
    v_cmp_gt_i32 s[68:69], 26, v231
    v_cndmask_b32 v76, v76, v242, s[64:65]
    v_cmp_gt_i32 s[64:65], 27, v231
    v_cndmask_b32 v77, v77, v242, s[66:67]
    v_cmp_gt_i32 s[66:67], 32, v231
    v_cndmask_b32 v78, v78, v242, s[68:69]
    v_cmp_gt_i32 s[68:69], 33, v231
    v_cndmask_b32 v79, v79, v242, s[64:65]
    s_waitcnt lgkmcnt(4)
    v_mfma_f32_32x32x16_bf16 v[32:47], v[216:219], v[144:147], v[32:47]
    ds_read_b64_tr_b16 v[212:213], v225 offset:54016
    ds_read_b64_tr_b16 v[214:215], v225 offset:56064
    v_cmp_gt_i32 s[64:65], 34, v231
    v_cndmask_b32 v80, v80, v242, s[66:67]
    v_cmp_gt_i32 s[66:67], 35, v231
    v_cndmask_b32 v81, v81, v242, s[68:69]
    v_cmp_gt_i32 s[68:69], 40, v231
    v_cndmask_b32 v82, v82, v242, s[64:65]
    v_cmp_gt_i32 s[64:65], 41, v231
    v_cndmask_b32 v83, v83, v242, s[66:67]
    v_cmp_gt_i32 s[66:67], 42, v231
    v_cndmask_b32 v84, v84, v242, s[68:69]
    v_cmp_gt_i32 s[68:69], 43, v231
    v_cndmask_b32 v85, v85, v242, s[64:65]
    s_waitcnt lgkmcnt(4)
    v_mfma_f32_32x32x16_bf16 v[48:63], v[220:223], v[144:147], v[48:63]
    ds_read_b64_tr_b16 v[216:217], v225 offset:54272
    ds_read_b64_tr_b16 v[218:219], v225 offset:56320
    v_cmp_gt_i32 s[64:65], 48, v231
    v_cndmask_b32 v86, v86, v242, s[66:67]
    v_cmp_gt_i32 s[66:67], 49, v231
    v_cndmask_b32 v87, v87, v242, s[68:69]
    v_cmp_gt_i32 s[68:69], 50, v231
    v_cndmask_b32 v88, v88, v242, s[64:65]
    v_cmp_gt_i32 s[64:65], 51, v231
    v_cndmask_b32 v89, v89, v242, s[66:67]
    v_cmp_gt_i32 s[66:67], 56, v231
    v_cndmask_b32 v90, v90, v242, s[68:69]
    v_cmp_gt_i32 s[68:69], 57, v231
    v_cndmask_b32 v91, v91, v242, s[64:65]
    s_waitcnt lgkmcnt(4)
    v_mfma_f32_32x32x16_bf16 v[0:15], v[208:211], v[148:151], v[0:15]
    ds_read_b64_tr_b16 v[220:221], v225 offset:54528
    ds_read_b64_tr_b16 v[222:223], v225 offset:56576
    v_cmp_gt_i32 s[64:65], 58, v231
    v_cndmask_b32 v92, v92, v242, s[66:67]
    v_cmp_gt_i32 s[66:67], 59, v231
    v_cndmask_b32 v93, v93, v242, s[68:69]
    v_cndmask_b32 v94, v94, v242, s[64:65]
    v_cndmask_b32 v95, v95, v242, s[66:67]
    v_max3_f32 v238, v64, v65, v66
    v_max3_f32 v238, v238, v67, v68
    v_max3_f32 v238, v238, v69, v70
    v_max_f32 v238, v238, v71
    v_max3_f32 v239, v72, v73, v74
    v_max3_f32 v239, v239, v75, v76
    s_waitcnt lgkmcnt(4)
    v_mfma_f32_32x32x16_bf16 v[16:31], v[212:215], v[148:151], v[16:31]
    ds_read_b64_tr_b16 v[208:209], v225 offset:57856
    ds_read_b64_tr_b16 v[210:211], v225 offset:59904
    v_max3_f32 v239, v239, v77, v78
    v_max_f32 v239, v239, v79
    v_max3_f32 v240, v80, v81, v82
    v_max3_f32 v240, v240, v83, v84
    v_max3_f32 v240, v240, v85, v86
    v_max_f32 v240, v240, v87
    v_max3_f32 v241, v88, v89, v90
    v_max3_f32 v241, v241, v91, v92
    v_max3_f32 v241, v241, v93, v94
    v_max_f32 v241, v241, v95
    v_max3_f32 v238, v238, v239, v240
    v_max_f32 v238, v238, v241
    s_waitcnt lgkmcnt(4)
    v_mfma_f32_32x32x16_bf16 v[32:47], v[216:219], v[148:151], v[32:47]
    ds_read_b64_tr_b16 v[212:213], v225 offset:58112
    ds_read_b64_tr_b16 v[214:215], v225 offset:60160
    v_mov_b32 v239, v238
    s_nop 1
    v_permlane32_swap_b32 v238, v239
    v_max_f32 v238, v238, v239
    v_cmp_gt_f32 vcc, v238, v234
    s_nop 0
    s_cbranch_vccnz L_rare9
L_back9:
    v_fma_f32 v64, v64, s53, -v233
    v_fma_f32 v65, v65, s53, -v233
    v_exp_f32 v64, v64
    v_fma_f32 v66, v66, s53, -v233
    v_exp_f32 v65, v65
    s_waitcnt lgkmcnt(4)
    v_mfma_f32_32x32x16_bf16 v[48:63], v[220:223], v[148:151], v[48:63]
    ds_read_b64_tr_b16 v[216:217], v225 offset:58368
    ds_read_b64_tr_b16 v[218:219], v225 offset:60416
    v_fma_f32 v67, v67, s53, -v233
    v_add_f32 v235, v235, v64
    v_exp_f32 v66, v66
    v_fma_f32 v68, v68, s53, -v233
    v_add_f32 v236, v236, v65
    v_cvt_pk_bf16_f32 v128, v64, v65
    v_exp_f32 v67, v67
    v_fma_f32 v69, v69, s53, -v233
    v_add_f32 v235, v235, v66
    v_exp_f32 v68, v68
    v_fma_f32 v70, v70, s53, -v233
    v_add_f32 v236, v236, v67
    s_waitcnt lgkmcnt(4)
    v_mfma_f32_32x32x16_bf16 v[0:15], v[208:211], v[152:155], v[0:15]
    ds_read_b64_tr_b16 v[220:221], v225 offset:58624
    ds_read_b64_tr_b16 v[222:223], v225 offset:60672
    v_cvt_pk_bf16_f32 v129, v66, v67
    v_exp_f32 v69, v69
    v_fma_f32 v71, v71, s53, -v233
    v_add_f32 v235, v235, v68
    v_exp_f32 v70, v70
    v_fma_f32 v72, v72, s53, -v233
    v_add_f32 v236, v236, v69
    v_cvt_pk_bf16_f32 v130, v68, v69
    v_exp_f32 v71, v71
    v_fma_f32 v73, v73, s53, -v233
    v_add_f32 v235, v235, v70
    v_exp_f32 v72, v72
    s_waitcnt lgkmcnt(4)
    v_mfma_f32_32x32x16_bf16 v[16:31], v[212:215], v[152:155], v[16:31]
    ds_read_b64_tr_b16 v[208:209], v225 offset:61952
    ds_read_b64_tr_b16 v[210:211], v225 offset:64000
    v_fma_f32 v74, v74, s53, -v233
    v_add_f32 v236, v236, v71
    v_cvt_pk_bf16_f32 v131, v70, v71
    v_exp_f32 v73, v73
    v_fma_f32 v75, v75, s53, -v233
    v_add_f32 v235, v235, v72
    v_exp_f32 v74, v74
    v_fma_f32 v76, v76, s53, -v233
    v_add_f32 v236, v236, v73
    v_cvt_pk_bf16_f32 v132, v72, v73
    v_exp_f32 v75, v75
    v_fma_f32 v77, v77, s53, -v233
    s_waitcnt lgkmcnt(4)
    v_mfma_f32_32x32x16_bf16 v[32:47], v[216:219], v[152:155], v[32:47]
    ds_read_b64_tr_b16 v[212:213], v225 offset:62208
    ds_read_b64_tr_b16 v[214:215], v225 offset:64256
    v_add_f32 v235, v235, v74
    v_exp_f32 v76, v76
    v_fma_f32 v78, v78, s53, -v233
    v_add_f32 v236, v236, v75
    v_cvt_pk_bf16_f32 v133, v74, v75
    v_exp_f32 v77, v77
    v_fma_f32 v79, v79, s53, -v233
    v_add_f32 v235, v235, v76
    v_exp_f32 v78, v78
    v_fma_f32 v80, v80, s53, -v233
    v_add_f32 v236, v236, v77
    v_cvt_pk_bf16_f32 v134, v76, v77
    s_waitcnt lgkmcnt(4)
    v_mfma_f32_32x32x16_bf16 v[48:63], v[220:223], v[152:155], v[48:63]
    ds_read_b64_tr_b16 v[216:217], v225 offset:62464
    ds_read_b64_tr_b16 v[218:219], v225 offset:64512
    v_exp_f32 v79, v79
    v_fma_f32 v81, v81, s53, -v233
    v_add_f32 v235, v235, v78
    v_exp_f32 v80, v80
    v_fma_f32 v82, v82, s53, -v233
    v_add_f32 v236, v236, v79
    v_cvt_pk_bf16_f32 v135, v78, v79
    v_exp_f32 v81, v81
    v_fma_f32 v83, v83, s53, -v233
    v_add_f32 v235, v235, v80
    v_exp_f32 v82, v82
    v_fma_f32 v84, v84, s53, -v233
    s_waitcnt lgkmcnt(4)
    v_mfma_f32_32x32x16_bf16 v[0:15], v[208:211], v[156:159], v[0:15]
    ds_read_b64_tr_b16 v[220:221], v225 offset:62720
    ds_read_b64_tr_b16 v[222:223], v225 offset:64768
    v_add_f32 v236, v236, v81
    v_cvt_pk_bf16_f32 v136, v80, v81
    v_exp_f32 v83, v83
    v_fma_f32 v85, v85, s53, -v233
    v_add_f32 v235, v235, v82
    v_exp_f32 v84, v84
    v_fma_f32 v86, v86, s53, -v233
    v_add_f32 v236, v236, v83
    v_cvt_pk_bf16_f32 v137, v82, v83
    v_exp_f32 v85, v85
    v_fma_f32 v87, v87, s53, -v233
    v_add_f32 v235, v235, v84
    s_waitcnt lgkmcnt(4)
    v_mfma_f32_32x32x16_bf16 v[16:31], v[212:215], v[156:159], v[16:31]
    v_exp_f32 v86, v86
    v_fma_f32 v88, v88, s53, -v233
    v_add_f32 v236, v236, v85
    v_cvt_pk_bf16_f32 v138, v84, v85
    v_exp_f32 v87, v87
    v_fma_f32 v89, v89, s53, -v233
    v_add_f32 v235, v235, v86
    v_exp_f32 v88, v88
    v_fma_f32 v90, v90, s53, -v233
    v_add_f32 v236, v236, v87
    v_cvt_pk_bf16_f32 v139, v86, v87
    v_exp_f32 v89, v89
    s_waitcnt lgkmcnt(2)
    v_mfma_f32_32x32x16_bf16 v[32:47], v[216:219], v[156:159], v[32:47]
    v_fma_f32 v91, v91, s53, -v233
    v_add_f32 v235, v235, v88
    v_exp_f32 v90, v90
    v_fma_f32 v92, v92, s53, -v233
    v_add_f32 v236, v236, v89
    v_cvt_pk_bf16_f32 v140, v88, v89
    v_exp_f32 v91, v91
    v_fma_f32 v93, v93, s53, -v233
    v_add_f32 v235, v235, v90
    v_exp_f32 v92, v92
    v_fma_f32 v94, v94, s53, -v233
    v_add_f32 v236, v236, v91
    s_waitcnt lgkmcnt(0)
    v_mfma_f32_32x32x16_bf16 v[48:63], v[220:223], v[156:159], v[48:63]
    v_cvt_pk_bf16_f32 v141, v90, v91
    v_exp_f32 v93, v93
    v_fma_f32 v95, v95, s53, -v233
    v_add_f32 v235, v235, v92
    v_exp_f32 v94, v94
    v_add_f32 v236, v236, v93
    v_cvt_pk_bf16_f32 v142, v92, v93
    v_exp_f32 v95, v95
    v_add_f32 v235, v235, v94
    v_add_f32 v236, v236, v95
    v_cvt_pk_bf16_f32 v143, v94, v95
    s_cmp_lg_u32 s56, 0
    s_cbranch_scc1 L_resc10
L_rback10:
    s_cmp_eq_u32 s85, 0
    s_cbranch_scc1 L_w0_11
    s_waitcnt vmcnt(12) lgkmcnt(0)
    s_branch L_wd_11
L_w0_11:
    s_waitcnt vmcnt(0) lgkmcnt(0)
L_wd_11:
    s_barrier
    s_branch L_epi0
L_last1:
    s_add_u32 m0, s60, 49664
    s_nop 0
    buffer_load_dwordx4 v226, s[16:19], s58 offen lds
    s_add_u32 m0, s60, 50688
    s_nop 0
    buffer_load_dwordx4 v227, s[16:19], s58 offen lds
    s_add_u32 m0, s60, 51712
    s_nop 0
    buffer_load_dwordx4 v228, s[16:19], s58 offen lds
    s_add_u32 m0, s60, 52736
    s_nop 0
    buffer_load_dwordx4 v229, s[16:19], s58 offen lds
    s_mov_b32 s85, 0
    s_cmp_eq_u32 s84, 0
    s_cbranch_scc1 L_nopflast1
    s_lshl_b32 s62, s41, 4
    s_add_u32 s62, s62, s73
    s_lshl_b32 s62, s62, 11
    s_lshl_b32 s63, s26, 8
    s_add_u32 s87, s62, s63
    s_lshl_b32 s62, s75, 6
    s_lshl_b32 s63, s43, 5
    s_add_u32 s62, s62, s63
    s_add_u32 s70, s62, s73
    s_lshl_b32 s70, s70, 12
    s_lshl_b32 s71, s26, 1
    s_add_u32 s71, s71, s42
    s_lshl_b32 s71, s71, 8
    s_add_u32 s88, s70, s71
    buffer_load_dwordx4 v[160:163], v230, s[8:11], s88 offen offset:0
    buffer_load_dwordx4 v[164:167], v230, s[8:11], s88 offen offset:32
    buffer_load_dwordx4 v[168:171], v230, s[8:11], s88 offen offset:64
    buffer_load_dwordx4 v[172:175], v230, s[8:11], s88 offen offset:96
    buffer_load_dwordx4 v[176:179], v230, s[8:11], s88 offen offset:128
    buffer_load_dwordx4 v[180:183], v230, s[8:11], s88 offen offset:160
    buffer_load_dwordx4 v[184:187], v230, s[8:11], s88 offen offset:192
    buffer_load_dwordx4 v[188:191], v230, s[8:11], s88 offen offset:224
    s_add_u32 m0, s59, 0
    s_nop 0
    buffer_load_dwordx4 v226, s[12:15], s87 offen lds
    s_add_u32 m0, s59, 1040
    s_nop 0
    buffer_load_dwordx4 v227, s[12:15], s87 offen lds
    s_add_u32 m0, s59, 2080
    s_nop 0
    buffer_load_dwordx4 v228, s[12:15], s87 offen lds
    s_add_u32 m0, s59, 3120
    s_nop 0
    buffer_load_dwordx4 v229, s[12:15], s87 offen lds
    s_mov_b32 s85, 12
    s_cmp_lt_u32 s84, 2
    s_cbranch_scc1 L_nopflast1
    s_add_u32 s87, s87, 131072
    s_add_u32 m0, s59, 16640
    s_nop 0
    buffer_load_dwordx4 v226, s[12:15], s87 offen lds
    s_add_u32 m0, s59, 17680
    s_nop 0
    buffer_load_dwordx4 v227, s[12:15], s87 offen lds
    s_add_u32 m0, s59, 18720
    s_nop 0
    buffer_load_dwordx4 v228, s[12:15], s87 offen lds
    s_add_u32 m0, s59, 19760
    s_nop 0
    buffer_load_dwordx4 v229, s[12:15], s87 offen lds
    s_mov_b32 s85, 16
L_nopflast1:
    ds_read_b64_tr_b16 v[208:209], v225 offset:33280
    ds_read_b64_tr_b16 v[210:211], v225 offset:35328
    ds_read_b64_tr_b16 v[212:213], v225 offset:33536
    ds_read_b64_tr_b16 v[214:215], v225 offset:35584
    ds_read_b64_tr_b16 v[216:217], v225 offset:33792
    ds_read_b64_tr_b16 v[218:219], v225 offset:35840
    v_cmp_gt_i32 s[64:65], 0, v231
    v_cmp_gt_i32 s[66:67], 1, v231
    v_cmp_gt_i32 s[68:69], 2, v231
    v_cndmask_b32 v96, v96, v242, s[64:65]
    v_cmp_gt_i32 s[64:65], 3, v231
    v_cndmask_b32 v97, v97, v242, s[66:67]
    v_cmp_gt_i32 s[66:67], 8, v231
    v_cndmask_b32 v98, v98, v242, s[68:69]
    v_cmp_gt_i32 s[68:69], 9, v231
    v_cndmask_b32 v99, v99, v242, s[64:65]
    s_waitcnt lgkmcnt(4)
    v_mfma_f32_32x32x16_bf16 v[0:15], v[208:211], v[128:131], v[0:15]
    ds_read_b64_tr_b16 v[220:221], v225 offset:34048
    ds_read_b64_tr_b16 v[222:223], v225 offset:36096
    v_cmp_gt_i32 s[64:65], 10, v231
    v_cndmask_b32 v100, v100, v242, s[66:67]
    v_cmp_gt_i32 s[66:67], 11, v231
    v_cndmask_b32 v101, v101, v242, s[68:69]
    v_cmp_gt_i32 s[68:69], 16, v231
    v_cndmask_b32 v102, v102, v242, s[64:65]
    v_cmp_gt_i32 s[64:65], 17, v231
    v_cndmask_b32 v103, v103, v242, s[66:67]
    v_cmp_gt_i32 s[66:67], 18, v231
    v_cndmask_b32 v104, v104, v242, s[68:69]
    v_cmp_gt_i32 s[68:69], 19, v231
    v_cndmask_b32 v105, v105, v242, s[64:65]
    s_waitcnt lgkmcnt(4)
    v_mfma_f32_32x32x16_bf16 v[16:31], v[212:215], v[128:131], v[16:31]
    ds_read_b64_tr_b16 v[208:209], v225 offset:37376
    ds_read_b64_tr_b16 v[210:211], v225 offset:39424
    v_cmp_gt_i32 s[64:65], 24, v231
    v_cndmask_b32 v106, v106, v242, s[66:67]
    v_cmp_gt_i32 s[66:67], 25, v231
    v_cndmask_b32 v107, v107, v242, s[68:69]
    v_cmp_gt_i32 s[68:69], 26, v231
    v_cndmask_b32 v108, v108, v242, s[64:65]
    v_cmp_gt_i32 s[64:65], 27, v231
    v_cndmask_b32 v109, v109, v242, s[66:67]
    v_cmp_gt_i32 s[66:67], 32, v231
    v_cndmask_b32 v110, v110, v242, s[68:69]
    v_cmp_gt_i32 s[68:69], 33, v231
    v_cndmask_b32 v111, v111, v242, s[64:65]
    s_waitcnt lgkmcnt(4)
    v_mfma_f32_32x32x16_bf16 v[32:47], v[216:219], v[128:131], v[32:47]
    ds_read_b64_tr_b16 v[212:213], v225 offset:37632
    ds_read_b64_tr_b16 v[214:215], v225 offset:39680
    v_cmp_gt_i32 s[64:65], 34, v231
    v_cndmask_b32 v112, v112, v242, s[66:67]
    v_cmp_gt_i32 s[66:67], 35, v231
    v_cndmask_b32 v113, v113, v242, s[68:69]
    v_cmp_gt_i32 s[68:69], 40, v231
    v_cndmask_b32 v114, v114, v242, s[64:65]
    v_cmp_gt_i32 s[64:65], 41, v231
    v_cndmask_b32 v115, v115, v242, s[66:67]
    v_cmp_gt_i32 s[66:67], 42, v231
    v_cndmask_b32 v116, v116, v242, s[68:69]
    v_cmp_gt_i32 s[68:69], 43, v231
    v_cndmask_b32 v117, v117, v242, s[64:65]
    s_waitcnt lgkmcnt(4)
    v_mfma_f32_32x32x16_bf16 v[48:63], v[220:223], v[128:131], v[48:63]
    ds_read_b64_tr_b16 v[216:217], v225 offset:37888
    ds_read_b64_tr_b16 v[218:219], v225 offset:39936
    v_cmp_gt_i32 s[64:65], 48, v231
    v_cndmask_b32 v118, v118, v242, s[66:67]
    v_cmp_gt_i32 s[66:67], 49, v231
    v_cndmask_b32 v119, v119, v242, s[68:69]
    v_cmp_gt_i32 s[68:69], 50, v231
    v_cndmask_b32 v120, v120, v242, s[64:65]
    v_cmp_gt_i32 s[64:65], 51, v231
    v_cndmask_b32 v121, v121, v242, s[66:67]
    v_cmp_gt_i32 s[66:67], 56, v231
    v_cndmask_b32 v122, v122, v242, s[68:69]
    v_cmp_gt_i32 s[68:69], 57, v231
    v_cndmask_b32 v123, v123, v242, s[64:65]
    s_waitcnt lgkmcnt(4)
    v_mfma_f32_32x32x16_bf16 v[0:15], v[208:211], v[132:135], v[0:15]
    ds_read_b64_tr_b16 v[220:221], v225 offset:38144
    ds_read_b64_tr_b16 v[222:223], v225 offset:40192
    v_cmp_gt_i32 s[64:65], 58, v231
    v_cndmask_b32 v124, v124, v242, s[66:67]
    v_cmp_gt_i32 s[66:67], 59, v231
    v_cndmask_b32 v125, v125, v242, s[68:69]
    v_cndmask_b32 v126, v126, v242, s[64:65]
    v_cndmask_b32 v127, v127, v242, s[66:67]
    v_max3_f32 v238, v96, v97, v98
    v_max3_f32 v238, v238, v99, v100
    v_max3_f32 v238, v238, v101, v102
    v_max_f32 v238, v238, v103
    v_max3_f32 v239, v104, v105, v106
    v_max3_f32 v239, v239, v107, v108
    s_waitcnt lgkmcnt(4)
    v_mfma_f32_32x32x16_bf16 v[16:31], v[212:215], v[132:135], v[16:31]
    ds_read_b64_tr_b16 v[208:209], v225 offset:41472
    ds_read_b64_tr_b16 v[210:211], v225 offset:43520
    v_max3_f32 v239, v239, v109, v110
    v_max_f32 v239, v239, v111
    v_max3_f32 v240, v112, v113, v114
    v_max3_f32 v240, v240, v115, v116
    v_max3_f32 v240, v240, v117, v118
    v_max_f32 v240, v240, v119
    v_max3_f32 v241, v120, v121, v122
    v_max3_f32 v241, v241, v123, v124
    v_max3_f32 v241, v241, v125, v126
    v_max_f32 v241, v241, v127
    v_max3_f32 v238, v238, v239, v240
    v_max_f32 v238, v238, v241
    s_waitcnt lgkmcnt(4)
    v_mfma_f32_32x32x16_bf16 v[32:47], v[216:219], v[132:135], v[32:47]
    ds_read_b64_tr_b16 v[212:213], v225 offset:41728
    ds_read_b64_tr_b16 v[214:215], v225 offset:43776
    v_mov_b32 v239, v238
    s_nop 1
    v_permlane32_swap_b32 v238, v239
    v_max_f32 v238, v238, v239
    v_cmp_gt_f32 vcc, v238, v234
    s_nop 0
    s_cbranch_vccnz L_rare12
L_back12:
    v_fma_f32 v96, v96, s53, -v233
    v_fma_f32 v97, v97, s53, -v233
    v_exp_f32 v96, v96
    v_fma_f32 v98, v98, s53, -v233
    v_exp_f32 v97, v97
    s_waitcnt lgkmcnt(4)
    v_mfma_f32_32x32x16_bf16 v[48:63], v[220:223], v[132:135], v[48:63]
    ds_read_b64_tr_b16 v[216:217], v225 offset:41984
    ds_read_b64_tr_b16 v[218:219], v225 offset:44032
    v_fma_f32 v99, v99, s53, -v233
    v_add_f32 v235, v235, v96
    v_exp_f32 v98, v98
    v_fma_f32 v100, v100, s53, -v233
    v_add_f32 v236, v236, v97
    v_cvt_pk_bf16_f32 v144, v96, v97
    v_exp_f32 v99, v99
    v_fma_f32 v101, v101, s53, -v233
    v_add_f32 v235, v235, v98
    v_exp_f32 v100, v100
    v_fma_f32 v102, v102, s53, -v233
    v_add_f32 v236, v236, v99
    s_waitcnt lgkmcnt(4)
    v_mfma_f32_32x32x16_bf16 v[0:15], v[208:211], v[136:139], v[0:15]
    ds_read_b64_tr_b16 v[220:221], v225 offset:42240
    ds_read_b64_tr_b16 v[222:223], v225 offset:44288
    v_cvt_pk_bf16_f32 v145, v98, v99
    v_exp_f32 v101, v101
    v_fma_f32 v103, v103, s53, -v233
    v_add_f32 v235, v235, v100
    v_exp_f32 v102, v102
    v_fma_f32 v104, v104, s53, -v233
    v_add_f32 v236, v236, v101
    v_cvt_pk_bf16_f32 v146, v100, v101
    v_exp_f32 v103, v103
    v_fma_f32 v105, v105, s53, -v233
    v_add_f32 v235, v235, v102
    v_exp_f32 v104, v104
    s_waitcnt lgkmcnt(4)
    v_mfma_f32_32x32x16_bf16 v[16:31], v[212:215], v[136:139], v[16:31]
    ds_read_b64_tr_b16 v[208:209], v225 offset:45568
    ds_read_b64_tr_b16 v[210:211], v225 offset:47616
    v_fma_f32 v106, v106, s53, -v233
    v_add_f32 v236, v236, v103
    v_cvt_pk_bf16_f32 v147, v102, v103
    v_exp_f32 v105, v105
    v_fma_f32 v107, v107, s53, -v233
    v_add_f32 v235, v235, v104
    v_exp_f32 v106, v106
    v_fma_f32 v108, v108, s53, -v233
    v_add_f32 v236, v236, v105
    v_cvt_pk_bf16_f32 v148, v104, v105
    v_exp_f32 v107, v107
    v_fma_f32 v109, v109, s53, -v233
    s_waitcnt lgkmcnt(4)
    v_mfma_f32_32x32x16_bf16 v[32:47], v[216:219], v[136:139], v[32:47]
    ds_read_b64_tr_b16 v[212:213], v225 offset:45824
    ds_read_b64_tr_b16 v[214:215], v225 offset:47872
    v_add_f32 v235, v235, v106
    v_exp_f32 v108, v108
    v_fma_f32 v110, v110, s53, -v233
    v_add_f32 v236, v236, v107
    v_cvt_pk_bf16_f32 v149, v106, v107
    v_exp_f32 v109, v109
    v_fma_f32 v111, v111, s53, -v233
    v_add_f32 v235, v235, v108
    v_exp_f32 v110, v110
    v_fma_f32 v112, v112, s53, -v233
    v_add_f32 v236, v236, v109
    v_cvt_pk_bf16_f32 v150, v108, v109
    s_waitcnt lgkmcnt(4)
    v_mfma_f32_32x32x16_bf16 v[48:63], v[220:223], v[136:139], v[48:63]
    ds_read_b64_tr_b16 v[216:217], v225 offset:46080
    ds_read_b64_tr_b16 v[218:219], v225 offset:48128
    v_exp_f32 v111, v111
    v_fma_f32 v113, v113, s53, -v233
    v_add_f32 v235, v235, v110
    v_exp_f32 v112, v112
    v_fma_f32 v114, v114, s53, -v233
    v_add_f32 v236, v236, v111
    v_cvt_pk_bf16_f32 v151, v110, v111
    v_exp_f32 v113, v113
    v_fma_f32 v115, v115, s53, -v233
    v_add_f32 v235, v235, v112
    v_exp_f32 v114, v114
    v_fma_f32 v116, v116, s53, -v233
    s_waitcnt lgkmcnt(4)
    v_mfma_f32_32x32x16_bf16 v[0:15], v[208:211], v[140:143], v[0:15]
    ds_read_b64_tr_b16 v[220:221], v225 offset:46336
    ds_read_b64_tr_b16 v[222:223], v225 offset:48384
    v_add_f32 v236, v236, v113
    v_cvt_pk_bf16_f32 v152, v112, v113
    v_exp_f32 v115, v115
    v_fma_f32 v117, v117, s53, -v233
    v_add_f32 v235, v235, v114
    v_exp_f32 v116, v116
    v_fma_f32 v118, v118, s53, -v233
    v_add_f32 v236, v236, v115
    v_cvt_pk_bf16_f32 v153, v114, v115
    v_exp_f32 v117, v117
    v_fma_f32 v119, v119, s53, -v233
    v_add_f32 v235, v235, v116
    s_waitcnt lgkmcnt(4)
    v_mfma_f32_32x32x16_bf16 v[16:31], v[212:215], v[140:143], v[16:31]
    v_exp_f32 v118, v118
    v_fma_f32 v120, v120, s53, -v233
    v_add_f32 v236, v236, v117
    v_cvt_pk_bf16_f32 v154, v116, v117
    v_exp_f32 v119, v119
    v_fma_f32 v121, v121, s53, -v233
    v_add_f32 v235, v235, v118
    v_exp_f32 v120, v120
    v_fma_f32 v122, v122, s53, -v233
    v_add_f32 v236, v236, v119
    v_cvt_pk_bf16_f32 v155, v118, v119
    v_exp_f32 v121, v121
    s_waitcnt lgkmcnt(2)
    v_mfma_f32_32x32x16_bf16 v[32:47], v[216:219], v[140:143], v[32:47]
    v_fma_f32 v123, v123, s53, -v233
    v_add_f32 v235, v235, v120
    v_exp_f32 v122, v122
    v_fma_f32 v124, v124, s53, -v233
    v_add_f32 v236, v236, v121
    v_cvt_pk_bf16_f32 v156, v120, v121
    v_exp_f32 v123, v123
    v_fma_f32 v125, v125, s53, -v233
    v_add_f32 v235, v235, v122
    v_exp_f32 v124, v124
    v_fma_f32 v126, v126, s53, -v233
    v_add_f32 v236, v236, v123
    s_waitcnt lgkmcnt(0)
    v_mfma_f32_32x32x16_bf16 v[48:63], v[220:223], v[140:143], v[48:63]
    v_cvt_pk_bf16_f32 v157, v122, v123
    v_exp_f32 v125, v125
    v_fma_f32 v127, v127, s53, -v233
    v_add_f32 v235, v235, v124
    v_exp_f32 v126, v126
    v_add_f32 v236, v236, v125
    v_cvt_pk_bf16_f32 v158, v124, v125
    v_exp_f32 v127, v127
    v_add_f32 v235, v235, v126
    v_add_f32 v236, v236, v127
    v_cvt_pk_bf16_f32 v159, v126, v127
    s_cmp_lg_u32 s56, 0
    s_cbranch_scc1 L_resc13
L_rback13:
    s_cmp_eq_u32 s85, 0
    s_cbranch_scc1 L_w0_14
    s_waitcnt vmcnt(12) lgkmcnt(0)
    s_branch L_wd_14
L_w0_14:
    s_waitcnt vmcnt(0) lgkmcnt(0)
L_wd_14:
    s_barrier
    s_branch L_epi1
L_only:
    s_add_u32 m0, s60, 33280
    s_nop 0
    buffer_load_dwordx4 v226, s[16:19], s58 offen lds
    s_add_u32 m0, s60, 34304
    s_nop 0
    buffer_load_dwordx4 v227, s[16:19], s58 offen lds
    s_add_u32 m0, s60, 35328
    s_nop 0
    buffer_load_dwordx4 v228, s[16:19], s58 offen lds
    s_add_u32 m0, s60, 36352
    s_nop 0
    buffer_load_dwordx4 v229, s[16:19], s58 offen lds
    s_mov_b32 s85, 0
    s_cmp_eq_u32 s84, 0
    s_cbranch_scc1 L_nopfonly
    s_lshl_b32 s62, s41, 4
    s_add_u32 s62, s62, s73
    s_lshl_b32 s62, s62, 11
    s_lshl_b32 s63, s26, 8
    s_add_u32 s87, s62, s63
    s_lshl_b32 s62, s75, 6
    s_lshl_b32 s63, s43, 5
    s_add_u32 s62, s62, s63
    s_add_u32 s70, s62, s73
    s_lshl_b32 s70, s70, 12
    s_lshl_b32 s71, s26, 1
    s_add_u32 s71, s71, s42
    s_lshl_b32 s71, s71, 8
    s_add_u32 s88, s70, s71
    buffer_load_dwordx4 v[160:163], v230, s[8:11], s88 offen offset:0
    buffer_load_dwordx4 v[164:167], v230, s[8:11], s88 offen offset:32
    buffer_load_dwordx4 v[168:171], v230, s[8:11], s88 offen offset:64
    buffer_load_dwordx4 v[172:175], v230, s[8:11], s88 offen offset:96
    buffer_load_dwordx4 v[176:179], v230, s[8:11], s88 offen offset:128
    buffer_load_dwordx4 v[180:183], v230, s[8:11], s88 offen offset:160
    buffer_load_dwordx4 v[184:187], v230, s[8:11], s88 offen offset:192
    buffer_load_dwordx4 v[188:191], v230, s[8:11], s88 offen offset:224
    s_add_u32 m0, s59, 0
    s_nop 0
    buffer_load_dwordx4 v226, s[12:15], s87 offen lds
    s_add_u32 m0, s59, 1040
    s_nop 0
    buffer_load_dwordx4 v227, s[12:15], s87 offen lds
    s_add_u32 m0, s59, 2080
    s_nop 0
    buffer_load_dwordx4 v228, s[12:15], s87 offen lds
    s_add_u32 m0, s59, 3120
    s_nop 0
    buffer_load_dwordx4 v229, s[12:15], s87 offen lds
    s_mov_b32 s85, 12
    s_cmp_lt_u32 s84, 2
    s_cbranch_scc1 L_nopfonly
    s_add_u32 s87, s87, 131072
    s_add_u32 m0, s59, 16640
    s_nop 0
    buffer_load_dwordx4 v226, s[12:15], s87 offen lds
    s_add_u32 m0, s59, 17680
    s_nop 0
    buffer_load_dwordx4 v227, s[12:15], s87 offen lds
    s_add_u32 m0, s59, 18720
    s_nop 0
    buffer_load_dwordx4 v228, s[12:15], s87 offen lds
    s_add_u32 m0, s59, 19760
    s_nop 0
    buffer_load_dwordx4 v229, s[12:15], s87 offen lds
    s_mov_b32 s85, 16
L_nopfonly:
    v_cmp_gt_i32 s[64:65], 0, v231
    v_cmp_gt_i32 s[66:67], 1, v231
    v_cmp_gt_i32 s[68:69], 2, v231
    v_cndmask_b32 v64, v64, v242, s[64:65]
    v_cmp_gt_i32 s[64:65], 3, v231
    v_cndmask_b32 v65, v65, v242, s[66:67]
    v_cmp_gt_i32 s[66:67], 8, v231
    v_cndmask_b32 v66, v66, v242, s[68:69]
    v_cmp_gt_i32 s[68:69], 9, v231
    v_cndmask_b32 v67, v67, v242, s[64:65]
    v_cmp_gt_i32 s[64:65], 10, v231
    v_cndmask_b32 v68, v68, v242, s[66:67]
    v_cmp_gt_i32 s[66:67], 11, v231
    v_cndmask_b32 v69, v69, v242, s[68:69]
    v_cmp_gt_i32 s[68:69], 16, v231
    v_cndmask_b32 v70, v70, v242, s[64:65]
    v_cmp_gt_i32 s[64:65], 17, v231
    v_cndmask_b32 v71, v71, v242, s[66:67]
    v_cmp_gt_i32 s[66:67], 18, v231
    v_cndmask_b32 v72, v72, v242, s[68:69]
    v_cmp_gt_i32 s[68:69], 19, v231
    v_cndmask_b32 v73, v73, v242, s[64:65]
    v_cmp_gt_i32 s[64:65], 24, v231
    v_cndmask_b32 v74, v74, v242, s[66:67]
    v_cmp_gt_i32 s[66:67], 25, v231
    v_cndmask_b32 v75, v75, v242, s[68:69]
    v_cmp_gt_i32 s[68:69], 26, v231
    v_cndmask_b32 v76, v76, v242, s[64:65]
    v_cmp_gt_i32 s[64:65], 27, v231
    v_cndmask_b32 v77, v77, v242, s[66:67]
    v_cmp_gt_i32 s[66:67], 32, v231
    v_cndmask_b32 v78, v78, v242, s[68:69]
    v_cmp_gt_i32 s[68:69], 33, v231
    v_cndmask_b32 v79, v79, v242, s[64:65]
    v_cmp_gt_i32 s[64:65], 34, v231
    v_cndmask_b32 v80, v80, v242, s[66:67]
    v_cmp_gt_i32 s[66:67], 35, v231
    v_cndmask_b32 v81, v81, v242, s[68:69]
    v_cmp_gt_i32 s[68:69], 40, v231
    v_cndmask_b32 v82, v82, v242, s[64:65]
    v_cmp_gt_i32 s[64:65], 41, v231
    v_cndmask_b32 v83, v83, v242, s[66:67]
    v_cmp_gt_i32 s[66:67], 42, v231
    v_cndmask_b32 v84, v84, v242, s[68:69]
    v_cmp_gt_i32 s[68:69], 43, v231
    v_cndmask_b32 v85, v85, v242, s[64:65]
    v_cmp_gt_i32 s[64:65], 48, v231
    v_cndmask_b32 v86, v86, v242, s[66:67]
    v_cmp_gt_i32 s[66:67], 49, v231
    v_cndmask_b32 v87, v87, v242, s[68:69]
    v_cmp_gt_i32 s[68:69], 50, v231
    v_cndmask_b32 v88, v88, v242, s[64:65]
    v_cmp_gt_i32 s[64:65], 51, v231
    v_cndmask_b32 v89, v89, v242, s[66:67]
    v_cmp_gt_i32 s[66:67], 56, v231
    v_cndmask_b32 v90, v90, v242, s[68:69]
    v_cmp_gt_i32 s[68:69], 57, v231
    v_cndmask_b32 v91, v91, v242, s[64:65]
    v_cmp_gt_i32 s[64:65], 58, v231
    v_cndmask_b32 v92, v92, v242, s[66:67]
    v_cmp_gt_i32 s[66:67], 59, v231
    v_cndmask_b32 v93, v93, v242, s[68:69]
    v_cndmask_b32 v94, v94, v242, s[64:65]
    v_cndmask_b32 v95, v95, v242, s[66:67]
    v_max3_f32 v238, v64, v65, v66
    v_max3_f32 v238, v238, v67, v68
    v_max3_f32 v238, v238, v69, v70
    v_max_f32 v238, v238, v71
    v_max3_f32 v239, v72, v73, v74
    v_max3_f32 v239, v239, v75, v76
    v_max3_f32 v239, v239, v77, v78
    v_max_f32 v239, v239, v79
    v_max3_f32 v240, v80, v81, v82
    v_max3_f32 v240, v240, v83, v84
    v_max3_f32 v240, v240, v85, v86
    v_max_f32 v240, v240, v87
    v_max3_f32 v241, v88, v89, v90
    v_max3_f32 v241, v241, v91, v92
    v_max3_f32 v241, v241, v93, v94
    v_max_f32 v241, v241, v95
    v_max3_f32 v238, v238, v239, v240
    v_max_f32 v238, v238, v241
    v_mov_b32 v239, v238
    s_nop 1
    v_permlane32_swap_b32 v238, v239
    v_max_f32 v238, v238, v239
    v_cmp_gt_f32 vcc, v238, v234
    s_nop 0
    s_cbranch_vccnz L_rare15
L_back15:
    v_fma_f32 v64, v64, s53, -v233
    v_fma_f32 v65, v65, s53, -v233
    v_exp_f32 v64, v64
    v_fma_f32 v66, v66, s53, -v233
    v_exp_f32 v65, v65
    v_fma_f32 v67, v67, s53, -v233
    v_add_f32 v235, v235, v64
    v_exp_f32 v66, v66
    v_fma_f32 v68, v68, s53, -v233
    v_add_f32 v236, v236, v65
    v_cvt_pk_bf16_f32 v128, v64, v65
    v_exp_f32 v67, v67
    v_fma_f32 v69, v69, s53, -v233
    v_add_f32 v235, v235, v66
    v_exp_f32 v68, v68
    v_fma_f32 v70, v70, s53, -v233
    v_add_f32 v236, v236, v67
    v_cvt_pk_bf16_f32 v129, v66, v67
    v_exp_f32 v69, v69
    v_fma_f32 v71, v71, s53, -v233
    v_add_f32 v235, v235, v68
    v_exp_f32 v70, v70
    v_fma_f32 v72, v72, s53, -v233
    v_add_f32 v236, v236, v69
    v_cvt_pk_bf16_f32 v130, v68, v69
    v_exp_f32 v71, v71
    v_fma_f32 v73, v73, s53, -v233
    v_add_f32 v235, v235, v70
    v_exp_f32 v72, v72
    v_fma_f32 v74, v74, s53, -v233
    v_add_f32 v236, v236, v71
    v_cvt_pk_bf16_f32 v131, v70, v71
    v_exp_f32 v73, v73
    v_fma_f32 v75, v75, s53, -v233
    v_add_f32 v235, v235, v72
    v_exp_f32 v74, v74
    v_fma_f32 v76, v76, s53, -v233
    v_add_f32 v236, v236, v73
    v_cvt_pk_bf16_f32 v132, v72, v73
    v_exp_f32 v75, v75
    v_fma_f32 v77, v77, s53, -v233
    v_add_f32 v235, v235, v74
    v_exp_f32 v76, v76
    v_fma_f32 v78, v78, s53, -v233
    v_add_f32 v236, v236, v75
    v_cvt_pk_bf16_f32 v133, v74, v75
    v_exp_f32 v77, v77
    v_fma_f32 v79, v79, s53, -v233
    v_add_f32 v235, v235, v76
    v_exp_f32 v78, v78
    v_fma_f32 v80, v80, s53, -v233
    v_add_f32 v236, v236, v77
    v_cvt_pk_bf16_f32 v134, v76, v77
    v_exp_f32 v79, v79
    v_fma_f32 v81, v81, s53, -v233
    v_add_f32 v235, v235, v78
    v_exp_f32 v80, v80
    v_fma_f32 v82, v82, s53, -v233
    v_add_f32 v236, v236, v79
    v_cvt_pk_bf16_f32 v135, v78, v79
    v_exp_f32 v81, v81
    v_fma_f32 v83, v83, s53, -v233
    v_add_f32 v235, v235, v80
    v_exp_f32 v82, v82
    v_fma_f32 v84, v84, s53, -v233
    v_add_f32 v236, v236, v81
    v_cvt_pk_bf16_f32 v136, v80, v81
    v_exp_f32 v83, v83
    v_fma_f32 v85, v85, s53, -v233
    v_add_f32 v235, v235, v82
    v_exp_f32 v84, v84
    v_fma_f32 v86, v86, s53, -v233
    v_add_f32 v236, v236, v83
    v_cvt_pk_bf16_f32 v137, v82, v83
    v_exp_f32 v85, v85
    v_fma_f32 v87, v87, s53, -v233
    v_add_f32 v235, v235, v84
    v_exp_f32 v86, v86
    v_fma_f32 v88, v88, s53, -v233
    v_add_f32 v236, v236, v85
    v_cvt_pk_bf16_f32 v138, v84, v85
    v_exp_f32 v87, v87
    v_fma_f32 v89, v89, s53, -v233
    v_add_f32 v235, v235, v86
    v_exp_f32 v88, v88
    v_fma_f32 v90, v90, s53, -v233
    v_add_f32 v236, v236, v87
    v_cvt_pk_bf16_f32 v139, v86, v87
    v_exp_f32 v89, v89
    v_fma_f32 v91, v91, s53, -v233
    v_add_f32 v235, v235, v88
    v_exp_f32 v90, v90
    v_fma_f32 v92, v92, s53, -v233
    v_add_f32 v236, v236, v89
    v_cvt_pk_bf16_f32 v140, v88, v89
    v_exp_f32 v91, v91
    v_fma_f32 v93, v93, s53, -v233
    v_add_f32 v235, v235, v90
    v_exp_f32 v92, v92
    v_fma_f32 v94, v94, s53, -v233
    v_add_f32 v236, v236, v91
    v_cvt_pk_bf16_f32 v141, v90, v91
    v_exp_f32 v93, v93
    v_fma_f32 v95, v95, s53, -v233
    v_add_f32 v235, v235, v92
    v_exp_f32 v94, v94
    v_add_f32 v236, v236, v93
    v_cvt_pk_bf16_f32 v142, v92, v93
    v_exp_f32 v95, v95
    v_add_f32 v235, v235, v94
    v_add_f32 v236, v236, v95
    v_cvt_pk_bf16_f32 v143, v94, v95
    s_cmp_lg_u32 s56, 0
    s_cbranch_scc1 L_resc16
L_rback16:
    s_cmp_eq_u32 s85, 0
    s_cbranch_scc1 L_w0_17
    s_waitcnt vmcnt(12) lgkmcnt(0)
    s_branch L_wd_17
L_w0_17:
    s_waitcnt vmcnt(0) lgkmcnt(0)
L_wd_17:
    s_barrier
L_epi0:
    ds_read_b64_tr_b16 v[208:209], v225 offset:33280
    ds_read_b64_tr_b16 v[210:211], v225 offset:35328
    ds_read_b64_tr_b16 v[212:213], v225 offset:33536
    ds_read_b64_tr_b16 v[214:215], v225 offset:35584
    ds_read_b64_tr_b16 v[216:217], v225 offset:33792
    ds_read_b64_tr_b16 v[218:219], v225 offset:35840
    s_waitcnt lgkmcnt(4)
    v_mfma_f32_32x32x16_bf16 v[0:15], v[208:211], v[128:131], v[0:15]
    ds_read_b64_tr_b16 v[220:221], v225 offset:34048
    ds_read_b64_tr_b16 v[222:223], v225 offset:36096
    s_waitcnt lgkmcnt(4)
    v_mfma_f32_32x32x16_bf16 v[16:31], v[212:215], v[128:131], v[16:31]
    ds_read_b64_tr_b16 v[208:209], v225 offset:37376
    ds_read_b64_tr_b16 v[210:211], v225 offset:39424
    s_waitcnt lgkmcnt(4)
    v_mfma_f32_32x32x16_bf16 v[32:47], v[216:219], v[128:131], v[32:47]
    ds_read_b64_tr_b16 v[212:213], v225 offset:37632
    ds_read_b64_tr_b16 v[214:215], v225 offset:39680
    s_waitcnt lgkmcnt(4)
    v_mfma_f32_32x32x16_bf16 v[48:63], v[220:223], v[128:131], v[48:63]
    ds_read_b64_tr_b16 v[216:217], v225 offset:37888
    ds_read_b64_tr_b16 v[218:219], v225 offset:39936
    s_waitcnt lgkmcnt(4)
    v_mfma_f32_32x32x16_bf16 v[0:15], v[208:211], v[132:135], v[0:15]
    ds_read_b64_tr_b16 v[220:221], v225 offset:38144
    ds_read_b64_tr_b16 v[222:223], v225 offset:40192
    s_waitcnt lgkmcnt(4)
    v_mfma_f32_32x32x16_bf16 v[16:31], v[212:215], v[132:135], v[16:31]
    ds_read_b64_tr_b16 v[208:209], v225 offset:41472
    ds_read_b64_tr_b16 v[210:211], v225 offset:43520
    s_waitcnt lgkmcnt(4)
    v_mfma_f32_32x32x16_bf16 v[32:47], v[216:219], v[132:135], v[32:47]
    ds_read_b64_tr_b16 v[212:213], v225 offset:41728
    ds_read_b64_tr_b16 v[214:215], v225 offset:43776
    s_waitcnt lgkmcnt(4)
    v_mfma_f32_32x32x16_bf16 v[48:63], v[220:223], v[132:135], v[48:63]
    ds_read_b64_tr_b16 v[216:217], v225 offset:41984
    ds_read_b64_tr_b16 v[218:219], v225 offset:44032
    s_waitcnt lgkmcnt(4)
    v_mfma_f32_32x32x16_bf16 v[0:15], v[208:211], v[136:139], v[0:15]
    ds_read_b64_tr_b16 v[220:221], v225 offset:42240
    ds_read_b64_tr_b16 v[222:223], v225 offset:44288
    s_waitcnt lgkmcnt(4)
    v_mfma_f32_32x32x16_bf16 v[16:31], v[212:215], v[136:139], v[16:31]
    ds_read_b64_tr_b16 v[208:209], v225 offset:45568
    ds_read_b64_tr_b16 v[210:211], v225 offset:47616
    s_waitcnt lgkmcnt(4)
    v_mfma_f32_32x32x16_bf16 v[32:47], v[216:219], v[136:139], v[32:47]
    ds_read_b64_tr_b16 v[212:213], v225 offset:45824
    ds_read_b64_tr_b16 v[214:215], v225 offset:47872
    s_waitcnt lgkmcnt(4)
    v_mfma_f32_32x32x16_bf16 v[48:63], v[220:223], v[136:139], v[48:63]
    ds_read_b64_tr_b16 v[216:217], v225 offset:46080
    ds_read_b64_tr_b16 v[218:219], v225 offset:48128
    s_waitcnt lgkmcnt(4)
    v_mfma_f32_32x32x16_bf16 v[0:15], v[208:211], v[140:143], v[0:15]
    ds_read_b64_tr_b16 v[220:221], v225 offset:46336
    ds_read_b64_tr_b16 v[222:223], v225 offset:48384
    s_waitcnt lgkmcnt(4)
    v_mfma_f32_32x32x16_bf16 v[16:31], v[212:215], v[140:143], v[16:31]
    s_waitcnt lgkmcnt(2)
    v_mfma_f32_32x32x16_bf16 v[32:47], v[216:219], v[140:143], v[32:47]
    s_waitcnt lgkmcnt(0)
    v_mfma_f32_32x32x16_bf16 v[48:63], v[220:223], v[140:143], v[48:63]
    s_branch L_final
L_epi1:
    ds_read_b64_tr_b16 v[208:209], v225 offset:49664
    ds_read_b64_tr_b16 v[210:211], v225 offset:51712
    ds_read_b64_tr_b16 v[212:213], v225 offset:49920
    ds_read_b64_tr_b16 v[214:215], v225 offset:51968
    ds_read_b64_tr_b16 v[216:217], v225 offset:50176
    ds_read_b64_tr_b16 v[218:219], v225 offset:52224
    s_waitcnt lgkmcnt(4)
    v_mfma_f32_32x32x16_bf16 v[0:15], v[208:211], v[144:147], v[0:15]
    ds_read_b64_tr_b16 v[220:221], v225 offset:50432
    ds_read_b64_tr_b16 v[222:223], v225 offset:52480
    s_waitcnt lgkmcnt(4)
    v_mfma_f32_32x32x16_bf16 v[16:31], v[212:215], v[144:147], v[16:31]
    ds_read_b64_tr_b16 v[208:209], v225 offset:53760
    ds_read_b64_tr_b16 v[210:211], v225 offset:55808
    s_waitcnt lgkmcnt(4)
    v_mfma_f32_32x32x16_bf16 v[32:47], v[216:219], v[144:147], v[32:47]
    ds_read_b64_tr_b16 v[212:213], v225 offset:54016
    ds_read_b64_tr_b16 v[214:215], v225 offset:56064
    s_waitcnt lgkmcnt(4)
    v_mfma_f32_32x32x16_bf16 v[48:63], v[220:223], v[144:147], v[48:63]
    ds_read_b64_tr_b16 v[216:217], v225 offset:54272
    ds_read_b64_tr_b16 v[218:219], v225 offset:56320
    s_waitcnt lgkmcnt(4)
    v_mfma_f32_32x32x16_bf16 v[0:15], v[208:211], v[148:151], v[0:15]
    ds_read_b64_tr_b16 v[220:221], v225 offset:54528
    ds_read_b64_tr_b16 v[222:223], v225 offset:56576
    s_waitcnt lgkmcnt(4)
    v_mfma_f32_32x32x16_bf16 v[16:31], v[212:215], v[148:151], v[16:31]
    ds_read_b64_tr_b16 v[208:209], v225 offset:57856
    ds_read_b64_tr_b16 v[210:211], v225 offset:59904
    s_waitcnt lgkmcnt(4)
    v_mfma_f32_32x32x16_bf16 v[32:47], v[216:219], v[148:151], v[32:47]
    ds_read_b64_tr_b16 v[212:213], v225 offset:58112
    ds_read_b64_tr_b16 v[214:215], v225 offset:60160
    s_waitcnt lgkmcnt(4)
    v_mfma_f32_32x32x16_bf16 v[48:63], v[220:223], v[148:151], v[48:63]
    ds_read_b64_tr_b16 v[216:217], v225 offset:58368
    ds_read_b64_tr_b16 v[218:219], v225 offset:60416
    s_waitcnt lgkmcnt(4)
    v_mfma_f32_32x32x16_bf16 v[0:15], v[208:211], v[152:155], v[0:15]
    ds_read_b64_tr_b16 v[220:221], v225 offset:58624
    ds_read_b64_tr_b16 v[222:223], v225 offset:60672
    s_waitcnt lgkmcnt(4)
    v_mfma_f32_32x32x16_bf16 v[16:31], v[212:215], v[152:155], v[16:31]
    ds_read_b64_tr_b16 v[208:209], v225 offset:61952
    ds_read_b64_tr_b16 v[210:211], v225 offset:64000
    s_waitcnt lgkmcnt(4)
    v_mfma_f32_32x32x16_bf16 v[32:47], v[216:219], v[152:155], v[32:47]
    ds_read_b64_tr_b16 v[212:213], v225 offset:62208
    ds_read_b64_tr_b16 v[214:215], v225 offset:64256
    s_waitcnt lgkmcnt(4)
    v_mfma_f32_32x32x16_bf16 v[48:63], v[220:223], v[152:155], v[48:63]
    ds_read_b64_tr_b16 v[216:217], v225 offset:62464
    ds_read_b64_tr_b16 v[218:219], v225 offset:64512
    s_waitcnt lgkmcnt(4)
    v_mfma_f32_32x32x16_bf16 v[0:15], v[208:211], v[156:159], v[0:15]
    ds_read_b64_tr_b16 v[220:221], v225 offset:62720
    ds_read_b64_tr_b16 v[222:223], v225 offset:64768
    s_waitcnt lgkmcnt(4)
    v_mfma_f32_32x32x16_bf16 v[16:31], v[212:215], v[156:159], v[16:31]
    s_waitcnt lgkmcnt(2)
    v_mfma_f32_32x32x16_bf16 v[32:47], v[216:219], v[156:159], v[32:47]
    s_waitcnt lgkmcnt(0)
    v_mfma_f32_32x32x16_bf16 v[48:63], v[220:223], v[156:159], v[48:63]
L_final:
    v_add_f32 v235, v235, v236
    v_mov_b32 v239, v235
    s_nop 1
    v_permlane32_swap_b32 v235, v239
    v_add_f32 v235, v235, v239
    v_rcp_f32 v238, v235
    s_nop 15
    s_nop 15
    v_and_b32 v243, 31, v251
    s_lshl_b32 s62, s28, 6
    s_lshl_b32 s63, s43, 5
    s_add_u32 s62, s62, s63
    v_add_u32 v243, s62, v243
    v_cmp_gt_u32 vcc, s31, v243
    v_mul_f32 v0, v0, v238
    v_mul_f32 v1, v1, v238
    v_mul_f32 v2, v2, v238
    v_mul_f32 v3, v3, v238
    v_mul_f32 v4, v4, v238
    v_mul_f32 v5, v5, v238
    v_mul_f32 v6, v6, v238
    v_mul_f32 v7, v7, v238
    v_mul_f32 v8, v8, v238
    v_mul_f32 v9, v9, v238
    v_mul_f32 v10, v10, v238
    v_mul_f32 v11, v11, v238
    v_mul_f32 v12, v12, v238
    v_mul_f32 v13, v13, v238
    v_mul_f32 v14, v14, v238
    v_mul_f32 v15, v15, v238
    v_cvt_pk_bf16_f32 v0, v0, v1
    v_cvt_pk_bf16_f32 v1, v2, v3
    v_cvt_pk_bf16_f32 v2, v4, v5
    v_cvt_pk_bf16_f32 v3, v6, v7
    v_cvt_pk_bf16_f32 v4, v8, v9
    v_cvt_pk_bf16_f32 v5, v10, v11
    v_cvt_pk_bf16_f32 v6, v12, v13
    v_cvt_pk_bf16_f32 v7, v14, v15
    v_mul_f32 v16, v16, v238
    v_mul_f32 v17, v17, v238
    v_mul_f32 v18, v18, v238
    v_mul_f32 v19, v19, v238
    v_mul_f32 v20, v20, v238
    v_mul_f32 v21, v21, v238
    v_mul_f32 v22, v22, v238
    v_mul_f32 v23, v23, v238
    v_mul_f32 v24, v24, v238
    v_mul_f32 v25, v25, v238
    v_mul_f32 v26, v26, v238
    v_mul_f32 v27, v27, v238
    v_mul_f32 v28, v28, v238
    v_mul_f32 v29, v29, v238
    v_mul_f32 v30, v30, v238
    v_mul_f32 v31, v31, v238
    v_cvt_pk_bf16_f32 v16, v16, v17
    v_cvt_pk_bf16_f32 v17, v18, v19
    v_cvt_pk_bf16_f32 v18, v20, v21
    v_cvt_pk_bf16_f32 v19, v22, v23
    v_cvt_pk_bf16_f32 v20, v24, v25
    v_cvt_pk_bf16_f32 v21, v26, v27
    v_cvt_pk_bf16_f32 v22, v28, v29
    v_cvt_pk_bf16_f32 v23, v30, v31
    v_mul_f32 v32, v32, v238
    v_mul_f32 v33, v33, v238
    v_mul_f32 v34, v34, v238
    v_mul_f32 v35, v35, v238
    v_mul_f32 v36, v36, v238
    v_mul_f32 v37, v37, v238
    v_mul_f32 v38, v38, v238
    v_mul_f32 v39, v39, v238
    v_mul_f32 v40, v40, v238
    v_mul_f32 v41, v41, v238
    v_mul_f32 v42, v42, v238
    v_mul_f32 v43, v43, v238
    v_mul_f32 v44, v44, v238
    v_mul_f32 v45, v45, v238
    v_mul_f32 v46, v46, v238
    v_mul_f32 v47, v47, v238
    v_cvt_pk_bf16_f32 v32, v32, v33
    v_cvt_pk_bf16_f32 v33, v34, v35
    v_cvt_pk_bf16_f32 v34, v36, v37
    v_cvt_pk_bf16_f32 v35, v38, v39
    v_cvt_pk_bf16_f32 v36, v40, v41
    v_cvt_pk_bf16_f32 v37, v42, v43
    v_cvt_pk_bf16_f32 v38, v44, v45
    v_cvt_pk_bf16_f32 v39, v46, v47
    v_mul_f32 v48, v48, v238
    v_mul_f32 v49, v49, v238
    v_mul_f32 v50, v50, v238
    v_mul_f32 v51, v51, v238
    v_mul_f32 v52, v52, v238
    v_mul_f32 v53, v53, v238
    v_mul_f32 v54, v54, v238
    v_mul_f32 v55, v55, v238
    v_mul_f32 v56, v56, v238
    v_mul_f32 v57, v57, v238
    v_mul_f32 v58, v58, v238
    v_mul_f32 v59, v59, v238
    v_mul_f32 v60, v60, v238
    v_mul_f32 v61, v61, v238
    v_mul_f32 v62, v62, v238
    v_mul_f32 v63, v63, v238
    v_cvt_pk_bf16_f32 v48, v48, v49
    v_cvt_pk_bf16_f32 v49, v50, v51
    v_cvt_pk_bf16_f32 v50, v52, v53
    v_cvt_pk_bf16_f32 v51, v54, v55
    v_cvt_pk_bf16_f32 v52, v56, v57
    v_cvt_pk_bf16_f32 v53, v58, v59
    v_cvt_pk_bf16_f32 v54, v60, v61
    v_cvt_pk_bf16_f32 v55, v62, v63
    s_nop 1
    v_permlane32_swap_b32 v0, v2
    v_permlane32_swap_b32 v1, v3
    v_permlane32_swap_b32 v4, v6
    v_permlane32_swap_b32 v5, v7
    v_permlane32_swap_b32 v16, v18
    v_permlane32_swap_b32 v17, v19
    v_permlane32_swap_b32 v20, v22
    v_permlane32_swap_b32 v21, v23
    v_permlane32_swap_b32 v32, v34
    v_permlane32_swap_b32 v33, v35
    v_permlane32_swap_b32 v36, v38
    v_permlane32_swap_b32 v37, v39
    v_permlane32_swap_b32 v48, v50
    v_permlane32_swap_b32 v49, v51
    v_permlane32_swap_b32 v52, v54
    v_permlane32_swap_b32 v53, v55
    s_and_saveexec_b64 s[64:65], vcc
    s_cbranch_execz L_nostore
    buffer_store_dwordx4 v[0:3], v230, s[20:23], s61 offen offset:0
    buffer_store_dwordx4 v[4:7], v230, s[20:23], s61 offen offset:32
    buffer_store_dwordx4 v[16:19], v230, s[20:23], s61 offen offset:64
    buffer_store_dwordx4 v[20:23], v230, s[20:23], s61 offen offset:96
    buffer_store_dwordx4 v[32:35], v230, s[20:23], s61 offen offset:128
    buffer_store_dwordx4 v[36:39], v230, s[20:23], s61 offen offset:160
    buffer_store_dwordx4 v[48:51], v230, s[20:23], s61 offen offset:192
    buffer_store_dwordx4 v[52:55], v230, s[20:23], s61 offen offset:224
L_nostore:
    s_mov_b64 exec, -1
    s_cmp_eq_u32 s84, 0
    s_cbranch_scc1 L_exit
    s_mov_b32 s30, s73
    s_mov_b32 s31, s74
    s_mov_b32 s28, s75
    s_mov_b32 s29, s84
    s_mov_b32 s84, 0
    s_mov_b32 s86, 1
    s_branch L_item
L_exit:
    s_endpgm
L_rare3:
    v_max_f32 v239, v238, v232
    v_mul_f32 v240, s53, v239
    v_sub_f32 v237, v233, v240
    v_exp_f32 v237, v237
    v_mov_b32 v232, v239
    v_mov_b32 v233, v240
    v_add_f32 v234, s54, v239
    v_mul_f32 v235, v235, v237
    v_mul_f32 v236, v236, v237
    s_mov_b32 s56, 1
    s_branch L_back3
L_resc4:
    s_nop 15
    s_nop 15
    v_mul_f32 v0, v0, v237
    v_mul_f32 v1, v1, v237
    v_mul_f32 v2, v2, v237
    v_mul_f32 v3, v3, v237
    v_mul_f32 v4, v4, v237
    v_mul_f32 v5, v5, v237
    v_mul_f32 v6, v6, v237
    v_mul_f32 v7, v7, v237
    v_mul_f32 v8, v8, v237
    v_mul_f32 v9, v9, v237
    v_mul_f32 v10, v10, v237
    v_mul_f32 v11, v11, v237
    v_mul_f32 v12, v12, v237
    v_mul_f32 v13, v13, v237
    v_mul_f32 v14, v14, v237
    v_mul_f32 v15, v15, v237
    v_mul_f32 v16, v16, v237
    v_mul_f32 v17, v17, v237
    v_mul_f32 v18, v18, v237
    v_mul_f32 v19, v19, v237
    v_mul_f32 v20, v20, v237
    v_mul_f32 v21, v21, v237
    v_mul_f32 v22, v22, v237
    v_mul_f32 v23, v23, v237
    v_mul_f32 v24, v24, v237
    v_mul_f32 v25, v25, v237
    v_mul_f32 v26, v26, v237
    v_mul_f32 v27, v27, v237
    v_mul_f32 v28, v28, v237
    v_mul_f32 v29, v29, v237
    v_mul_f32 v30, v30, v237
    v_mul_f32 v31, v31, v237
    v_mul_f32 v32, v32, v237
    v_mul_f32 v33, v33, v237
    v_mul_f32 v34, v34, v237
    v_mul_f32 v35, v35, v237
    v_mul_f32 v36, v36, v237
    v_mul_f32 v37, v37, v237
    v_mul_f32 v38, v38, v237
    v_mul_f32 v39, v39, v237
    v_mul_f32 v40, v40, v237
    v_mul_f32 v41, v41, v237
    v_mul_f32 v42, v42, v237
    v_mul_f32 v43, v43, v237
    v_mul_f32 v44, v44, v237
    v_mul_f32 v45, v45, v237
    v_mul_f32 v46, v46, v237
    v_mul_f32 v47, v47, v237
    v_mul_f32 v48, v48, v237
    v_mul_f32 v49, v49, v237
    v_mul_f32 v50, v50, v237
    v_mul_f32 v51, v51, v237
    v_mul_f32 v52, v52, v237
    v_mul_f32 v53, v53, v237
    v_mul_f32 v54, v54, v237
    v_mul_f32 v55, v55, v237
    v_mul_f32 v56, v56, v237
    v_mul_f32 v57, v57, v237
    v_mul_f32 v58, v58, v237
    v_mul_f32 v59, v59, v237
    v_mul_f32 v60, v60, v237
    v_mul_f32 v61, v61, v237
    v_mul_f32 v62, v62, v237
    v_mul_f32 v63, v63, v237
    s_mov_b32 s56, 0
    s_nop 1
    s_branch L_rback4
L_rare5:
    v_max_f32 v239, v238, v232
    v_mul_f32 v240, s53, v239
    v_sub_f32 v237, v233, v240
    v_exp_f32 v237, v237
    v_mov_b32 v232, v239
    v_mov_b32 v233, v240
    v_add_f32 v234, s54, v239
    v_mul_f32 v235, v235, v237
    v_mul_f32 v236, v236, v237
    s_mov_b32 s56, 1
    s_branch L_back5
L_resc6:
    s_nop 15
    s_nop 15
    v_mul_f32 v0, v0, v237
    v_mul_f32 v1, v1, v237
    v_mul_f32 v2, v2, v237
    v_mul_f32 v3, v3, v237
    v_mul_f32 v4, v4, v237
    v_mul_f32 v5, v5, v237
    v_mul_f32 v6, v6, v237
    v_mul_f32 v7, v7, v237
    v_mul_f32 v8, v8, v237
    v_mul_f32 v9, v9, v237
    v_mul_f32 v10, v10, v237
    v_mul_f32 v11, v11, v237
    v_mul_f32 v12, v12, v237
    v_mul_f32 v13, v13, v237
    v_mul_f32 v14, v14, v237
    v_mul_f32 v15, v15, v237
    v_mul_f32 v16, v16, v237
    v_mul_f32 v17, v17, v237
    v_mul_f32 v18, v18, v237
    v_mul_f32 v19, v19, v237
    v_mul_f32 v20, v20, v237
    v_mul_f32 v21, v21, v237
    v_mul_f32 v22, v22, v237
    v_mul_f32 v23, v23, v237
    v_mul_f32 v24, v24, v237
    v_mul_f32 v25, v25, v237
    v_mul_f32 v26, v26, v237
    v_mul_f32 v27, v27, v237
    v_mul_f32 v28, v28, v237
    v_mul_f32 v29, v29, v237
    v_mul_f32 v30, v30, v237
    v_mul_f32 v31, v31, v237
    v_mul_f32 v32, v32, v237
    v_mul_f32 v33, v33, v237
    v_mul_f32 v34, v34, v237
    v_mul_f32 v35, v35, v237
    v_mul_f32 v36, v36, v237
    v_mul_f32 v37, v37, v237
    v_mul_f32 v38, v38, v237
    v_mul_f32 v39, v39, v237
    v_mul_f32 v40, v40, v237
    v_mul_f32 v41, v41, v237
    v_mul_f32 v42, v42, v237
    v_mul_f32 v43, v43, v237
    v_mul_f32 v44, v44, v237
    v_mul_f32 v45, v45, v237
    v_mul_f32 v46, v46, v237
    v_mul_f32 v47, v47, v237
    v_mul_f32 v48, v48, v237
    v_mul_f32 v49, v49, v237
    v_mul_f32 v50, v50, v237
    v_mul_f32 v51, v51, v237
    v_mul_f32 v52, v52, v237
    v_mul_f32 v53, v53, v237
    v_mul_f32 v54, v54, v237
    v_mul_f32 v55, v55, v237
    v_mul_f32 v56, v56, v237
    v_mul_f32 v57, v57, v237
    v_mul_f32 v58, v58, v237
    v_mul_f32 v59, v59, v237
    v_mul_f32 v60, v60, v237
    v_mul_f32 v61, v61, v237
    v_mul_f32 v62, v62, v237
    v_mul_f32 v63, v63, v237
    s_mov_b32 s56, 0
    s_nop 1
    s_branch L_rback6
L_rare7:
    v_max_f32 v239, v238, v232
    v_mul_f32 v240, s53, v239
    v_sub_f32 v237, v233, v240
    v_exp_f32 v237, v237
    v_mov_b32 v232, v239
    v_mov_b32 v233, v240
    v_add_f32 v234, s54, v239
    v_mul_f32 v235, v235, v237
    v_mul_f32 v236, v236, v237
    s_mov_b32 s56, 1
    s_branch L_back7
L_resc8:
    s_nop 15
    s_nop 15
    v_mul_f32 v0, v0, v237
    v_mul_f32 v1, v1, v237
    v_mul_f32 v2, v2, v237
    v_mul_f32 v3, v3, v237
    v_mul_f32 v4, v4, v237
    v_mul_f32 v5, v5, v237
    v_mul_f32 v6, v6, v237
    v_mul_f32 v7, v7, v237
    v_mul_f32 v8, v8, v237
    v_mul_f32 v9, v9, v237
    v_mul_f32 v10, v10, v237
    v_mul_f32 v11, v11, v237
    v_mul_f32 v12, v12, v237
    v_mul_f32 v13, v13, v237
    v_mul_f32 v14, v14, v237
    v_mul_f32 v15, v15, v237
    v_mul_f32 v16, v16, v237
    v_mul_f32 v17, v17, v237
    v_mul_f32 v18, v18, v237
    v_mul_f32 v19, v19, v237
    v_mul_f32 v20, v20, v237
    v_mul_f32 v21, v21, v237
    v_mul_f32 v22, v22, v237
    v_mul_f32 v23, v23, v237
    v_mul_f32 v24, v24, v237
    v_mul_f32 v25, v25, v237
    v_mul_f32 v26, v26, v237
    v_mul_f32 v27, v27, v237
    v_mul_f32 v28, v28, v237
    v_mul_f32 v29, v29, v237
    v_mul_f32 v30, v30, v237
    v_mul_f32 v31, v31, v237
    v_mul_f32 v32, v32, v237
    v_mul_f32 v33, v33, v237
    v_mul_f32 v34, v34, v237
    v_mul_f32 v35, v35, v237
    v_mul_f32 v36, v36, v237
    v_mul_f32 v37, v37, v237
    v_mul_f32 v38, v38, v237
    v_mul_f32 v39, v39, v237
    v_mul_f32 v40, v40, v237
    v_mul_f32 v41, v41, v237
    v_mul_f32 v42, v42, v237
    v_mul_f32 v43, v43, v237
    v_mul_f32 v44, v44, v237
    v_mul_f32 v45, v45, v237
    v_mul_f32 v46, v46, v237
    v_mul_f32 v47, v47, v237
    v_mul_f32 v48, v48, v237
    v_mul_f32 v49, v49, v237
    v_mul_f32 v50, v50, v237
    v_mul_f32 v51, v51, v237
    v_mul_f32 v52, v52, v237
    v_mul_f32 v53, v53, v237
    v_mul_f32 v54, v54, v237
    v_mul_f32 v55, v55, v237
    v_mul_f32 v56, v56, v237
    v_mul_f32 v57, v57, v237
    v_mul_f32 v58, v58, v237
    v_mul_f32 v59, v59, v237
    v_mul_f32 v60, v60, v237
    v_mul_f32 v61, v61, v237
    v_mul_f32 v62, v62, v237
    v_mul_f32 v63, v63, v237
    s_mov_b32 s56, 0
    s_nop 1
    s_branch L_rback8
L_rare9:
    v_max_f32 v239, v238, v232
    v_mul_f32 v240, s53, v239
    v_sub_f32 v237, v233, v240
    v_exp_f32 v237, v237
    v_mov_b32 v232, v239
    v_mov_b32 v233, v240
    v_add_f32 v234, s54, v239
    v_mul_f32 v235, v235, v237
    v_mul_f32 v236, v236, v237
    s_mov_b32 s56, 1
    s_branch L_back9
L_resc10:
    s_nop 15
    s_nop 15
    v_mul_f32 v0, v0, v237
    v_mul_f32 v1, v1, v237
    v_mul_f32 v2, v2, v237
    v_mul_f32 v3, v3, v237
    v_mul_f32 v4, v4, v237
    v_mul_f32 v5, v5, v237
    v_mul_f32 v6, v6, v237
    v_mul_f32 v7, v7, v237
    v_mul_f32 v8, v8, v237
    v_mul_f32 v9, v9, v237
    v_mul_f32 v10, v10, v237
    v_mul_f32 v11, v11, v237
    v_mul_f32 v12, v12, v237
    v_mul_f32 v13, v13, v237
    v_mul_f32 v14, v14, v237
    v_mul_f32 v15, v15, v237
    v_mul_f32 v16, v16, v237
    v_mul_f32 v17, v17, v237
    v_mul_f32 v18, v18, v237
    v_mul_f32 v19, v19, v237
    v_mul_f32 v20, v20, v237
    v_mul_f32 v21, v21, v237
    v_mul_f32 v22, v22, v237
    v_mul_f32 v23, v23, v237
    v_mul_f32 v24, v24, v237
    v_mul_f32 v25, v25, v237
    v_mul_f32 v26, v26, v237
    v_mul_f32 v27, v27, v237
    v_mul_f32 v28, v28, v237
    v_mul_f32 v29, v29, v237
    v_mul_f32 v30, v30, v237
    v_mul_f32 v31, v31, v237
    v_mul_f32 v32, v32, v237
    v_mul_f32 v33, v33, v237
    v_mul_f32 v34, v34, v237
    v_mul_f32 v35, v35, v237
    v_mul_f32 v36, v36, v237
    v_mul_f32 v37, v37, v237
    v_mul_f32 v38, v38, v237
    v_mul_f32 v39, v39, v237
    v_mul_f32 v40, v40, v237
    v_mul_f32 v41, v41, v237
    v_mul_f32 v42, v42, v237
    v_mul_f32 v43, v43, v237
    v_mul_f32 v44, v44, v237
    v_mul_f32 v45, v45, v237
    v_mul_f32 v46, v46, v237
    v_mul_f32 v47, v47, v237
    v_mul_f32 v48, v48, v237
    v_mul_f32 v49, v49, v237
    v_mul_f32 v50, v50, v237
    v_mul_f32 v51, v51, v237
    v_mul_f32 v52, v52, v237
    v_mul_f32 v53, v53, v237
    v_mul_f32 v54, v54, v237
    v_mul_f32 v55, v55, v237
    v_mul_f32 v56, v56, v237
    v_mul_f32 v57, v57, v237
    v_mul_f32 v58, v58, v237
    v_mul_f32 v59, v59, v237
    v_mul_f32 v60, v60, v237
    v_mul_f32 v61, v61, v237
    v_mul_f32 v62, v62, v237
    v_mul_f32 v63, v63, v237
    s_mov_b32 s56, 0
    s_nop 1
    s_branch L_rback10
L_rare12:
    v_max_f32 v239, v238, v232
    v_mul_f32 v240, s53, v239
    v_sub_f32 v237, v233, v240
    v_exp_f32 v237, v237
    v_mov_b32 v232, v239
    v_mov_b32 v233, v240
    v_add_f32 v234, s54, v239
    v_mul_f32 v235, v235, v237
    v_mul_f32 v236, v236, v237
    s_mov_b32 s56, 1
    s_branch L_back12
L_resc13:
    s_nop 15
    s_nop 15
    v_mul_f32 v0, v0, v237
    v_mul_f32 v1, v1, v237
    v_mul_f32 v2, v2, v237
    v_mul_f32 v3, v3, v237
    v_mul_f32 v4, v4, v237
    v_mul_f32 v5, v5, v237
    v_mul_f32 v6, v6, v237
    v_mul_f32 v7, v7, v237
    v_mul_f32 v8, v8, v237
    v_mul_f32 v9, v9, v237
    v_mul_f32 v10, v10, v237
    v_mul_f32 v11, v11, v237
    v_mul_f32 v12, v12, v237
    v_mul_f32 v13, v13, v237
    v_mul_f32 v14, v14, v237
    v_mul_f32 v15, v15, v237
    v_mul_f32 v16, v16, v237
    v_mul_f32 v17, v17, v237
    v_mul_f32 v18, v18, v237
    v_mul_f32 v19, v19, v237
    v_mul_f32 v20, v20, v237
    v_mul_f32 v21, v21, v237
    v_mul_f32 v22, v22, v237
    v_mul_f32 v23, v23, v237
    v_mul_f32 v24, v24, v237
    v_mul_f32 v25, v25, v237
    v_mul_f32 v26, v26, v237
    v_mul_f32 v27, v27, v237
    v_mul_f32 v28, v28, v237
    v_mul_f32 v29, v29, v237
    v_mul_f32 v30, v30, v237
    v_mul_f32 v31, v31, v237
    v_mul_f32 v32, v32, v237
    v_mul_f32 v33, v33, v237
    v_mul_f32 v34, v34, v237
    v_mul_f32 v35, v35, v237
    v_mul_f32 v36, v36, v237
    v_mul_f32 v37, v37, v237
    v_mul_f32 v38, v38, v237
    v_mul_f32 v39, v39, v237
    v_mul_f32 v40, v40, v237
    v_mul_f32 v41, v41, v237
    v_mul_f32 v42, v42, v237
    v_mul_f32 v43, v43, v237
    v_mul_f32 v44, v44, v237
    v_mul_f32 v45, v45, v237
    v_mul_f32 v46, v46, v237
    v_mul_f32 v47, v47, v237
    v_mul_f32 v48, v48, v237
    v_mul_f32 v49, v49, v237
    v_mul_f32 v50, v50, v237
    v_mul_f32 v51, v51, v237
    v_mul_f32 v52, v52, v237
    v_mul_f32 v53, v53, v237
    v_mul_f32 v54, v54, v237
    v_mul_f32 v55, v55, v237
    v_mul_f32 v56, v56, v237
    v_mul_f32 v57, v57, v237
    v_mul_f32 v58, v58, v237
    v_mul_f32 v59, v59, v237
    v_mul_f32 v60, v60, v237
    v_mul_f32 v61, v61, v237
    v_mul_f32 v62, v62, v237
    v_mul_f32 v63, v63, v237
    s_mov_b32 s56, 0
    s_nop 1
    s_branch L_rback13
L_rare15:
    v_max_f32 v239, v238, v232
    v_mul_f32 v240, s53, v239
    v_sub_f32 v237, v233, v240
    v_exp_f32 v237, v237
    v_mov_b32 v232, v239
    v_mov_b32 v233, v240
    v_add_f32 v234, s54, v239
    v_mul_f32 v235, v235, v237
    v_mul_f32 v236, v236, v237
    s_mov_b32 s56, 1
    s_branch L_back15
L_resc16:
    s_nop 15
    s_nop 15
    v_mul_f32 v0, v0, v237
    v_mul_f32 v1, v1, v237
    v_mul_f32 v2, v2, v237
    v_mul_f32 v3, v3, v237
    v_mul_f32 v4, v4, v237
    v_mul_f32 v5, v5, v237
    v_mul_f32 v6, v6, v237
    v_mul_f32 v7, v7, v237
    v_mul_f32 v8, v8, v237
    v_mul_f32 v9, v9, v237
    v_mul_f32 v10, v10, v237
    v_mul_f32 v11, v11, v237
    v_mul_f32 v12, v12, v237
    v_mul_f32 v13, v13, v237
    v_mul_f32 v14, v14, v237
    v_mul_f32 v15, v15, v237
    v_mul_f32 v16, v16, v237
    v_mul_f32 v17, v17, v237
    v_mul_f32 v18, v18, v237
    v_mul_f32 v19, v19, v237
    v_mul_f32 v20, v20, v237
    v_mul_f32 v21, v21, v237
    v_mul_f32 v22, v22, v237
    v_mul_f32 v23, v23, v237
    v_mul_f32 v24, v24, v237
    v_mul_f32 v25, v25, v237
    v_mul_f32 v26, v26, v237
    v_mul_f32 v27, v27, v237
    v_mul_f32 v28, v28, v237
    v_mul_f32 v29, v29, v237
    v_mul_f32 v30, v30, v237
    v_mul_f32 v31, v31, v237
    v_mul_f32 v32, v32, v237
    v_mul_f32 v33, v33, v237
    v_mul_f32 v34, v34, v237
    v_mul_f32 v35, v35, v237
    v_mul_f32 v36, v36, v237
    v_mul_f32 v37, v37, v237
    v_mul_f32 v38, v38, v237
    v_mul_f32 v39, v39, v237
    v_mul_f32 v40, v40, v237
    v_mul_f32 v41, v41, v237
    v_mul_f32 v42, v42, v237
    v_mul_f32 v43, v43, v237
    v_mul_f32 v44, v44, v237
    v_mul_f32 v45, v45, v237
    v_mul_f32 v46, v46, v237
    v_mul_f32 v47, v47, v237
    v_mul_f32 v48, v48, v237
    v_mul_f32 v49, v49, v237
    v_mul_f32 v50, v50, v237
    v_mul_f32 v51, v51, v237
    v_mul_f32 v52, v52, v237
    v_mul_f32 v53, v53, v237
    v_mul_f32 v54, v54, v237
    v_mul_f32 v55, v55, v237
    v_mul_f32 v56, v56, v237
    v_mul_f32 v57, v57, v237
    v_mul_f32 v58, v58, v237
    v_mul_f32 v59, v59, v237
    v_mul_f32 v60, v60, v237
    v_mul_f32 v61, v61, v237
    v_mul_f32 v62, v62, v237
    v_mul_f32 v63, v63, v237
    s_mov_b32 s56, 0
    s_nop 1
    s_branch L_rback16
.section .rodata,"a"
.p2align 6
.amdhsa_kernel standalone__ragged_sequences_varlen_flash_attn__ragged_kernel
  .amdhsa_next_free_vgpr 256
  .amdhsa_next_free_sgpr 96
  .amdhsa_accum_offset 256
  .amdhsa_group_segment_fixed_size 0
  .amdhsa_kernarg_size 56
  .amdhsa_user_sgpr_count 2
  .amdhsa_user_sgpr_kernarg_segment_ptr 1
  .amdhsa_system_sgpr_workgroup_id_x 1
.end_amdhsa_kernel
```
